```python
import torch

def _softmax(x, axis=-1):
    return torch.softmax(x, dim=axis)

def _gelu(x):
    return torch.nn.functional.gelu(x, approximate='tanh')

def _silu(x):
    return torch.nn.functional.silu(x)

def _sigmoid(x):
    return torch.sigmoid(x)

def _layernorm(x, axis=-1, eps=1e-05):
    m = x.mean(dim=axis, keepdim=True)
    v = x.var(dim=axis, keepdim=True, unbiased=False)
    return (x - m) / torch.sqrt(v + eps)

def _scatter_add(tgt, idx, src, axis=0):
    return tgt.clone().index_add_(axis, idx, src)

def _segment_sum(src, seg, n):
    out = torch.zeros((n,) + src.shape[1:], dtype=src.dtype)
    return out.index_add_(0, seg, src)

def _pad(x, pw):
    flat = tuple((v for pair in reversed(pw) for v in pair))
    return torch.nn.functional.pad(x, flat)
kernel_name = 'adaLN_cond__grouped_kv_mqa__moe_arch_mod__prompt'

def setup_inputs():

    _w = lambda a: (lambda t: t.to(torch.bfloat16) if t.is_floating_point() else t)(torch.as_tensor(a))

    def _A_setup():
        B, S, D, H = (1, 2048, 640, 32)
        Dh = D // H
        return {'x': _w((lambda *s: torch.randn(*s, dtype=torch.bfloat16) * 0.05)(B, S, D)), 'wq': _w((lambda *s: torch.randn(*s, dtype=torch.bfloat16) * 0.05)(D, H * Dh)), 'wk': _w((lambda *s: torch.randn(*s, dtype=torch.bfloat16) * 0.05)(D, Dh)), 'wv': _w((lambda *s: torch.randn(*s, dtype=torch.bfloat16) * 0.05)(D, Dh)), 'wo': _w((lambda *s: torch.randn(*s, dtype=torch.bfloat16) * 0.05)(H * Dh, D))}
    _A_in = _A_setup()

    def _B_setup():
        B, S, D, F, C = (1, 2048, 640, 1728, 1)
        return {'x': _w((lambda *s: torch.randn(*s, dtype=torch.bfloat16) * 0.05)(B, S, D)), 'w_r': _w((lambda *s: torch.randn(*s, dtype=torch.bfloat16) * 0.05)(D)), 'w_gate': _w((lambda *s: torch.randn(*s, dtype=torch.bfloat16) * 0.05)(D, F)), 'w_up': _w((lambda *s: torch.randn(*s, dtype=torch.bfloat16) * 0.05)(D, F)), 'w_down': _w((lambda *s: torch.randn(*s, dtype=torch.bfloat16) * 0.05)(F, D))}
    _B_in = _B_setup()
    return {'A_x': _A_in['x'], 'A_wq': _A_in['wq'], 'A_wk': _A_in['wk'], 'A_wv': _A_in['wv'], 'A_wo': _A_in['wo'], 'B_x': _B_in['x'], 'B_w_r': _B_in['w_r'], 'B_w_gate': _B_in['w_gate'], 'B_w_up': _B_in['w_up'], 'B_w_down': _B_in['w_down'], 'c': _w((lambda *s: torch.randn(*s, dtype=torch.bfloat16) * 0.1)(1, 640) * 8.0), 'w_mod': _w((lambda *s: torch.randn(*s, dtype=torch.bfloat16) * 0.1)(640, 6 * 640) * 640 ** (-0.5) * 8.0)}

def reference(A_x, A_wq, A_wk, A_wv, A_wo, B_x, B_w_r, B_w_gate, B_w_up, B_w_down, c, w_mod):

    def _A_ref(x, wq, wk, wv, wo):
        B, S, D = x.shape
        H = 32
        Dh = D // H
        q = (lambda x, *d: x.permute(*d))((x @ wq).reshape(B, S, H, Dh), 0, 2, 1, 3)
        k = x @ wk
        v = x @ wv
        scores = torch.einsum('bhqd,bkd->bhqk', q, k) * Dh ** (-0.5)
        p = _softmax(scores, axis=-1)
        o = torch.einsum('bhqk,bkd->bhqd', p, v)
        return (lambda x, *d: x.permute(*d))(o, 0, 2, 1, 3).reshape(B, S, H * Dh) @ wo

    def _B_ref(x, w_r, w_gate, w_up, w_down):
        B, S, D = x.shape
        C = 1
        r = x @ w_r
        idx = torch.argsort(-r, axis=-1)[:, :C]
        idx_e = (lambda x, n, axis: torch.repeat_interleave(x, n, dim=axis))(idx.reshape(B, C, 1), D, axis=2)
        x_sel = (lambda x, i, axis: torch.take_along_dim(x, i, dim=axis))(x, idx_e, axis=1)
        g = _silu(x_sel @ w_gate)
        u = x_sel @ w_up
        y = g * u @ w_down
        r_sel = _sigmoid((lambda x, i, axis: torch.take_along_dim(x, i, dim=axis))(r, idx, axis=1))
        y = y * r_sel.reshape(B, C, 1)
        b_off = (torch.arange(B) * S).reshape(B, 1)
        flat_idx = (idx + b_off).reshape(B * C)
        zero = (x * 0.0).reshape(B * S, D)
        upd = _scatter_add(zero, flat_idx, y.reshape(B * C, D), axis=0)
        return x + upd.reshape(B, S, D)
    x = A_x
    mod = (_silu(c) @ w_mod).reshape(c.shape[0], 6, 1, -1)
    sa, ca, ga, sb, cb, gb = (mod[:, 0].clone(), mod[:, 1].clone(), mod[:, 2].clone(), mod[:, 3].clone(), mod[:, 4].clone(), mod[:, 5].clone())
    h = _layernorm(x, axis=-1) * (1 + ca) + sa
    x = x + ga * _A_ref(h, A_wq, A_wk, A_wv, A_wo)
    h = _layernorm(x, axis=-1) * (1 + cb) + sb
    x = x + gb * _B_ref(h, B_w_r, B_w_gate, B_w_up, B_w_down)
    return x
```

```asm
; @launch grid=(256,1,1) block=(512,1,1) lds=163840
.amdgcn_target "amdgcn-amd-amdhsa--gfx950"
.text
.globl adaLN_cond__grouped_kv_mqa__moe_arch_mod__prompt_kernel
.p2align 8
.type adaLN_cond__grouped_kv_mqa__moe_arch_mod__prompt_kernel,@function
adaLN_cond__grouped_kv_mqa__moe_arch_mod__prompt_kernel:
    s_cmp_ge_u32 s2, 256
    s_cbranch_scc1 L_exit
    s_load_dwordx8 s[24:31], s[0:1], 64
    s_load_dwordx16 s[8:23], s[0:1], 0
    s_load_dwordx4 s[32:35], s[0:1], 96
    s_load_dwordx2 s[36:37], s[0:1], 112
    s_lshr_b32 s59, s2, 3
    s_getpc_b64 s[4:5]
L_pc:
    s_mul_i32 s58, s59, 1280
    v_min_u32 v4, 9, v0
    v_lshl_add_u32 v4, v4, 7, s58
    v_min_u32 v4, L_codeend-L_pc-4, v4
    global_load_dword v104, v4, s[4:5]
    v_lshrrev_b32 v4, 6, v0
    v_and_b32 v1, 63, v0
    v_mov_b32 v9, 0
    v_mov_b32 v6, 0
    v_lshlrev_b32 v5, 2, v1
    v_add_u32 v5, 160256, v5
    ds_write_b32 v5, v6
    v_readfirstlane_b32 s38, v4
    s_and_b32 s58, s2, 7
    s_and_b32 s42, s59, 7
    s_lshr_b32 s59, s59, 3
    s_lshl_b32 s60, s58, 2
    s_add_u32 s41, s60, s59
    s_lshl_b32 s61, s59, 5
    s_add_u32 s61, s61, s60
    s_add_u32 s82, s61, s42
    s_and_b32 s39, s38, 3
    s_lshr_b32 s40, s38, 2
    s_lshl_b32 s73, s41, 3
    s_add_u32 s73, s73, s42
    s_cmp_lg_u32 s40, 0
    s_cbranch_scc1 L_proQ
    s_setprio 3
    v_min_u32 v102, 39, v1
    s_mul_i32 s58, s39, 320
    v_lshl_add_u32 v102, v102, 3, s58
    s_cmp_ge_u32 s42, 4
    s_cbranch_scc1 L_proK
    v_lshrrev_b32 v105, 1, v1
    s_mul_i32 s59, s39, 160
    v_add_u32 v105, s59, v105
    v_mul_u32_u24 v105, 7680, v105
    v_and_b32 v4, 1, v1
    v_lshl_add_u32 v105, v4, 4, v105
    s_lshl_b32 s59, s82, 5
    v_add_u32 v105, s59, v105
    s_mul_i32 s60, s39, 5120
    s_add_u32 s60, s60, 102400
    s_waitcnt lgkmcnt(0)
    global_load_dwordx2 v[100:101], v102, s[28:29]
    s_barrier
    s_cmp_ge_u32 s82, 80
    s_cbranch_scc1 L_setup
    s_add_u32 s58, s42, 0
    s_cmp_ge_u32 s58, 5
    s_cselect_b32 s59, 5, 0
    s_sub_u32 s58, s58, s59
    s_lshl_b32 s59, s58, 10
    s_mul_i32 s58, s58, 245760
    s_add_u32 m0, s60, s59
    v_add_u32 v4, s58, v105
    global_load_lds_dwordx4 v4, s[30:31]
    s_add_u32 s58, s42, 1
    s_cmp_ge_u32 s58, 5
    s_cselect_b32 s59, 5, 0
    s_sub_u32 s58, s58, s59
    s_lshl_b32 s59, s58, 10
    s_mul_i32 s58, s58, 245760
    s_add_u32 m0, s60, s59
    v_add_u32 v4, s58, v105
    global_load_lds_dwordx4 v4, s[30:31]
    s_add_u32 s58, s42, 2
    s_cmp_ge_u32 s58, 5
    s_cselect_b32 s59, 5, 0
    s_sub_u32 s58, s58, s59
    s_lshl_b32 s59, s58, 10
    s_mul_i32 s58, s58, 245760
    s_add_u32 m0, s60, s59
    v_add_u32 v4, s58, v105
    global_load_lds_dwordx4 v4, s[30:31]
    s_add_u32 s58, s42, 3
    s_cmp_ge_u32 s58, 5
    s_cselect_b32 s59, 5, 0
    s_sub_u32 s58, s58, s59
    s_lshl_b32 s59, s58, 10
    s_mul_i32 s58, s58, 245760
    s_add_u32 m0, s60, s59
    v_add_u32 v4, s58, v105
    global_load_lds_dwordx4 v4, s[30:31]
    s_add_u32 s58, s42, 4
    s_cmp_ge_u32 s58, 5
    s_cselect_b32 s59, 5, 0
    s_sub_u32 s58, s58, s59
    s_lshl_b32 s59, s58, 10
    s_mul_i32 s58, s58, 245760
    s_add_u32 m0, s60, s59
    v_add_u32 v4, s58, v105
    global_load_lds_dwordx4 v4, s[30:31]
    s_branch L_setup
L_proK:
    s_and_b32 s58, s42, 3
    s_lshl_b32 s59, s59, 1
    s_lshr_b32 s60, s58, 1
    s_add_u32 s59, s59, s60
    s_lshl_b32 s59, s59, 2
    s_add_u32 s59, s59, s39
    s_mul_i32 s59, s59, 896
    s_min_u32 s59, s59, 24704
    v_min_u32 v10, 6, v1
    v_lshl_add_u32 v10, v10, 7, s59
    s_lshl_b32 s58, s58, 2
    s_add_u32 s58, s58, s39
    s_mul_i32 s58, s58, 40
    v_min_u32 v9, 39, v1
    v_add_u32 v9, s58, v9
    v_mul_u32_u24 v9, 7680, v9
    s_lshl_b32 s58, s61, 5
    v_add_u32 v9, s58, v9
    s_waitcnt lgkmcnt(0)
    s_bitcmp1_b32 s42, 0
    s_cselect_b64 s[52:53], s[14:15], s[12:13]
    s_cmp_ge_u32 s61, 80
    s_cbranch_scc1 L_nohelp
    global_load_dword v103, v9, s[30:31]
L_nohelp:
    global_load_dword v105, v10, s[52:53]
    global_load_dwordx2 v[100:101], v102, s[28:29]
    s_barrier
    s_branch L_setup
L_proQ:
    s_setprio 3
    s_mul_i32 s58, s73, 10240
    s_mul_i32 s59, s39, 2560
    s_add_u32 s58, s58, s59
    v_min_u32 v9, 19, v1
    v_lshl_add_u32 v9, v9, 7, s58
    s_lshl_b32 s58, s2, 7
    s_lshl_b32 s59, s39, 15
    s_add_u32 s58, s58, s59
    s_add_u32 s58, s58, 4096
    v_mov_b32 v10, s58
    s_waitcnt lgkmcnt(0)
    global_load_dword v105, v10, s[36:37] sc1
    s_barrier
L_setup:
    s_load_dword s43, s[36:37], 0
    v_and_b32 v2, 15, v1
    v_lshrrev_b32 v3, 4, v1
    s_and_b32 s70, s38, 1
    s_lshr_b32 s71, s39, 1
    s_and_b32 s58, s2, 7
    s_lshl_b32 s83, s58, 3
    s_or_b32 s83, s83, s42
    s_and_b32 s60, s2, 0xc0
    s_or_b32 s83, s83, s60
    v_add_u32 v4, 0, v1
    v_mul_u32_u24 v5, 6554, v4
    v_lshrrev_b32 v5, 16, v5
    v_mul_u32_u24 v6, 10, v5
    v_sub_u32 v6, v4, v6
    v_and_b32 v7, 12, v5
    v_lshlrev_b32 v7, 1, v7
    v_and_or_b32 v7, v5, 3, v7
    v_lshrrev_b32 v5, 2, v5
    v_and_or_b32 v7, v5, 4, v7
    v_mul_u32_u24 v7, 1280, v7
    v_lshl_add_u32 v232, v6, 4, v7
    v_add_u32 v4, 64, v1
    v_mul_u32_u24 v5, 6554, v4
    v_lshrrev_b32 v5, 16, v5
    v_mul_u32_u24 v6, 10, v5
    v_sub_u32 v6, v4, v6
    v_and_b32 v7, 12, v5
    v_lshlrev_b32 v7, 1, v7
    v_and_or_b32 v7, v5, 3, v7
    v_lshrrev_b32 v5, 2, v5
    v_and_or_b32 v7, v5, 4, v7
    v_mul_u32_u24 v7, 1280, v7
    v_lshl_add_u32 v233, v6, 4, v7
    v_add_u32 v4, 128, v1
    v_mul_u32_u24 v5, 6554, v4
    v_lshrrev_b32 v5, 16, v5
    v_mul_u32_u24 v6, 10, v5
    v_sub_u32 v6, v4, v6
    v_and_b32 v7, 12, v5
    v_lshlrev_b32 v7, 1, v7
    v_and_or_b32 v7, v5, 3, v7
    v_lshrrev_b32 v5, 2, v5
    v_and_or_b32 v7, v5, 4, v7
    v_mul_u32_u24 v7, 1280, v7
    v_lshl_add_u32 v234, v6, 4, v7
    v_add_u32 v4, 192, v1
    v_mul_u32_u24 v5, 6554, v4
    v_lshrrev_b32 v5, 16, v5
    v_mul_u32_u24 v6, 10, v5
    v_sub_u32 v6, v4, v6
    v_and_b32 v7, 12, v5
    v_lshlrev_b32 v7, 1, v7
    v_and_or_b32 v7, v5, 3, v7
    v_lshrrev_b32 v5, 2, v5
    v_and_or_b32 v7, v5, 4, v7
    v_mul_u32_u24 v7, 1280, v7
    v_lshl_add_u32 v235, v6, 4, v7
    v_add_u32 v4, 256, v1
    v_mul_u32_u24 v5, 6554, v4
    v_lshrrev_b32 v5, 16, v5
    v_mul_u32_u24 v6, 10, v5
    v_sub_u32 v6, v4, v6
    v_and_b32 v7, 12, v5
    v_lshlrev_b32 v7, 1, v7
    v_and_or_b32 v7, v5, 3, v7
    v_lshrrev_b32 v5, 2, v5
    v_and_or_b32 v7, v5, 4, v7
    v_mul_u32_u24 v7, 1280, v7
    v_lshl_add_u32 v236, v6, 4, v7
    s_cmp_eq_u32 s40, 0
    s_cbranch_scc1 L_ntx
    global_load_dword v103, v9, s[8:9]
L_ntx:
    v_cmp_eq_u32 s[74:75], 0, v2
    s_mov_b32 s76, -1
    s_mov_b32 s77, 0
    s_lshl_b32 s72, s40, 2
    s_add_u32 s72, s72, 160260
    s_getreg_b32 s91, hwreg(HW_REG_XCC_ID)
    v_mov_b32 v239, s91
    s_and_b32 s58, s2, 6
    s_lshl_b32 s58, s58, 1
    s_and_b32 s59, s42, 3
    s_or_b32 s58, s58, s59
    s_lshr_b32 s59, s2, 5
    s_lshl_b32 s59, s59, 4
    s_or_b32 s58, s58, s59
    s_cmp_lt_u32 s58, 108
    s_cselect_b32 s59, 0, 48
    s_cmp_lt_u32 s58, 80
    s_cselect_b32 s60, 176, 28
    s_bitcmp1_b32 s2, 0
    s_cselect_b32 s59, s59, s60
    s_add_u32 s97, s58, s59
    v_lshlrev_b32 v240, 4, v1
    v_lshlrev_b32 v241, 3, v1
    v_lshrrev_b32 v4, 5, v1
    v_and_b32 v5, 31, v1
    v_mul_u32_u24 v242, 336, v4
    v_lshl_add_u32 v242, v5, 4, v242
    v_add_u32 v242, 2688, v242
    v_mov_b32 v6, 0x40000000
    v_cmp_gt_u32 vcc, 21, v5
    v_mov_b32 v243, 0xdddddddd
    s_add_u32 s48, s36, 262144
    v_cndmask_b32 v242, v6, v242, vcc
    s_addc_u32 s49, s37, 0
    s_mov_b32 s50, 3407872
    s_mov_b32 s51, 0x20000
    s_mov_b32 s44, 0
    s_mov_b32 s45, 0
    v_add_u32 v247, 139264, v240
    s_lshl_b32 s58, s39, 2
    s_add_u32 s58, s58, 141312
    v_lshl_add_u32 v14, v5, 4, s58
    v_lshlrev_b32 v6, 11, v4
    v_sub_u32 v14, v14, v6
    s_lshl_b32 s58, s39, 9
    s_add_u32 s58, s58, 139264
    v_lshl_add_u32 v244, v5, 4, s58
    s_lshl_b32 s58, s41, 1
    s_add_u32 s58, s58, s40
    s_mul_i32 s59, s58, 40960
    s_mul_i32 s60, s42, 2560
    s_add_u32 s59, s59, s60
    s_lshr_b32 s60, s39, 1
    s_mul_i32 s60, s60, 1280
    s_add_u32 s59, s59, s60
    s_add_u32 s59, s59, 524288
    v_and_b32 v6, 1, v3
    v_mul_u32_u24 v6, 20480, v6
    v_lshl_add_u32 v6, v2, 4, v6
    s_and_b32 s60, s39, 1
    s_lshl_b32 s61, s60, 3
    s_add_u32 s61, s61, s59
    v_add_u32 v246, s61, v6
    s_mul_i32 s60, s60, 768
    s_add_u32 s59, s59, s60
    v_lshl_add_u32 v6, v4, 8, v6
    v_add_u32 v245, s59, v6
    s_add_u32 s58, s39, 1
    s_and_b32 s58, s58, 3
    s_mul_i32 s59, s58, 9216
    s_add_u32 s59, s59, 102400
    v_add_u32 v248, s59, v240
    s_lshl_b32 s59, s58, 9
    v_add_u32 v252, s59, v14
    s_add_u32 s58, s39, 2
    s_and_b32 s58, s58, 3
    s_mul_i32 s59, s58, 9216
    s_add_u32 s59, s59, 102400
    v_add_u32 v249, s59, v240
    s_lshl_b32 s59, s58, 9
    v_add_u32 v253, s59, v14
    s_add_u32 s58, s39, 3
    s_and_b32 s58, s58, 3
    s_mul_i32 s59, s58, 9216
    s_add_u32 s59, s59, 102400
    v_add_u32 v250, s59, v240
    s_lshl_b32 s59, s58, 9
    v_add_u32 v254, s59, v14
    s_add_u32 s58, s39, 4
    s_and_b32 s58, s58, 3
    s_mul_i32 s59, s58, 9216
    s_add_u32 s59, s59, 102400
    v_add_u32 v251, s59, v240
    s_lshl_b32 s59, s58, 9
    v_add_u32 v255, s59, v14
    v_lshrrev_b32 v6, 2, v2
    v_lshrrev_b32 v4, 1, v6
    v_xor_b32 v5, v6, v4
    v_and_b32 v5, 1, v5
    v_lshl_or_b32 v4, v5, 1, v4
    v_xor_b32 v4, v4, v3
    v_lshlrev_b32 v4, 4, v4
    v_lshl_add_u32 v4, v2, 6, v4
    s_mul_i32 s58, s38, 10240
    v_add_u32 v184, s58, v4
    v_cmp_eq_u32 s[84:85], v6, v3
    s_lshl_b32 s58, s38, 7
    s_add_u32 s58, s58, 159232
    v_lshl_add_u32 v185, v2, 3, s58
    s_lshl_b32 s59, s71, 8
    s_sub_u32 s58, s58, s59
    v_lshl_add_u32 v186, v2, 3, s58
    v_lshl_add_u32 v4, v3, 3, v6
    v_mul_u32_u24 v5, 40, v4
    v_and_b32 v4, 3, v2
    v_cmp_eq_u32 s[86:87], 1, v4
    v_cmp_eq_u32 s[54:55], 2, v4
    v_cmp_eq_u32 s[56:57], 3, v4
    v_lshlrev_b32 v4, 3, v4
    s_bitcmp1_b32 s42, 1
    s_cselect_b64 vcc, -1, 0
    v_cndmask_b32 v4, v4, 32, vcc
    s_mul_i32 s58, s71, 12800
    s_add_u32 s58, s58, 102400
    v_add3_u32 v187, v5, v4, s58
    v_mul_u32_u24 v8, 40, v1
    s_mul_i32 s58, s71, 51200
    v_add_u32 v8, s58, v8
    s_mul_i32 s58, s71, 1280
    s_add_u32 s58, s58, 152576
    v_lshl_add_u32 v10, v3, 5, s58
    s_lshl_b32 s58, s40, 10
    s_add_u32 s58, s58, 2048
    s_mul_i32 s58, s58, s70
    s_lshl_b32 s59, s40, 12
    s_add_u32 s58, s58, s59
    s_lshl_b32 s59, s71, 10
    s_add_u32 s58, s58, s59
    s_add_u32 s58, s58, 138240
    v_add_u32 v9, s58, v240
    v_min_u32 v4, 39, v1
    s_mul_i32 s58, s39, 40
    v_add_u32 v4, s58, v4
    v_lshrrev_b32 v14, 1, v4
    v_lshlrev_b32 v14, 7, v14
    v_and_b32 v5, 1, v4
    v_lshl_add_u32 v14, v5, 5, v14
    v_add_u32 v14, 4096, v14
    v_lshlrev_b32 v15, 5, v4
    v_add_u32 v15, 152576, v15
    v_mov_b64 v[106:107], 0
    v_mov_b64 v[108:109], 0
    v_mov_b32 v11, 0
    v_mov_b32 v237, 0
    s_cmp_eq_u32 s40, 0
    s_cbranch_scc1 L_setupE
    s_lshl_b32 s58, s41, 6
    s_lshl_b32 s59, s70, 4
    s_add_u32 s58, s58, s59
    v_lshrrev_b32 v106, 2, v1
    v_add_u32 v106, s58, v106
    v_mul_u32_u24 v106, 1280, v106
    v_lshrrev_b32 v4, 1, v3
    v_xor_b32 v5, v3, v4
    v_and_b32 v5, 1, v5
    v_lshl_or_b32 v4, v5, 1, v4
    v_xor_b32 v4, v4, v1
    v_and_b32 v4, 3, v4
    s_mul_i32 s59, s71, 640
    v_lshl_add_u32 v106, v4, 4, v106
    v_add_u32 v106, s59, v106
    v_add_u32 v107, 40960, v106
    s_and_b32 s58, s41, 3
    s_lshl_b32 s58, s58, 2
    s_and_b32 s59, s42, 3
    s_add_u32 s58, s58, s59
    s_lshl_b32 s58, s58, 2
    s_add_u32 s58, s58, s39
    s_mul_i32 s58, s58, 12800
    v_min_u32 v108, 49, v1
    v_lshl_add_u32 v108, v108, 8, s58
    s_and_b32 s58, s42, 3
    s_lshl_b32 s58, s58, 2
    s_add_u32 s58, s58, s39
    s_mul_i32 s58, s58, 384
    s_min_u32 s58, s58, 4992
    s_mul_i32 s59, s41, 5376
    s_add_u32 s58, s58, s59
    s_add_u32 s58, s58, 262144
    v_min_u32 v109, 2, v1
    v_lshl_add_u32 v109, v109, 7, s58
    v_lshl_add_u32 v7, s70, 4, v2
    v_lshrrev_b32 v4, 1, v3
    v_and_b32 v5, 1, v3
    s_mov_b64 s[78:79], -1
    s_mov_b64 s[80:81], 0
    v_mov_b32 v12, 0x3f803f80
    v_mov_b32 v13, 0x3f803f80
    s_bitcmp1_b32 s42, 0
    s_cbranch_scc1 L_kvaV
    s_bitcmp1_b32 s42, 1
    s_cbranch_scc1 L_kvaKr
    s_lshl_b32 s58, s71, 10
    v_lshl_add_u32 v11, v4, 9, s58
    v_lshl_add_u32 v11, v7, 4, v11
    v_lshl_add_u32 v11, v5, 3, v11
    s_branch L_kvaE
L_kvaKr:
    s_lshl_b32 s58, s71, 8
    s_add_u32 s58, s58, 2048
    v_lshl_add_u32 v11, v7, 3, s58
    s_mov_b64 s[78:79], 0xffff
    s_branch L_kvaE
L_kvaV:
    s_mul_i32 s58, s39, 672
    s_add_u32 s58, s58, 2688
    v_mul_u32_u24 v11, 336, v4
    v_lshl_add_u32 v11, v2, 4, v11
    v_lshl_add_u32 v11, v5, 3, v11
    v_add_u32 v11, s58, v11
    s_bitcmp1_b32 s42, 1
    s_cbranch_scc0 L_kvaE
    v_add_u32 v11, 256, v11
    v_cmp_ge_u32 s[78:79], 4, v2
    v_cmp_eq_u32 s[80:81], 4, v2
L_kvaE:
    s_mul_i32 s58, s41, 5376
    s_add_u32 s58, s58, 262144
    v_add_u32 v11, s58, v11
    s_lshl_b32 s58, s73, 7
    s_add_u32 s58, s58, 36864
    v_lshl_add_u32 v237, v1, 3, s58
L_setupE:
    v_mov_b32 v136, 0x3f803f80
    v_mov_b32 v137, 0x3f803f80
    v_mov_b32 v138, 0x3f803f80
    v_mov_b32 v139, 0x3f803f80
    s_cmp_lg_u32 s40, 0
    s_cbranch_scc1 L_xQ
    s_cmp_lt_u32 s42, 4
    s_cselect_b32 s46, s82, 255
    s_cbranch_scc1 L_nowkv
    s_bitcmp1_b32 s42, 0
    s_cselect_b64 s[52:53], s[14:15], s[12:13]
    s_mul_i32 s58, s39, 7
    s_add_u32 s59, s58, 0
    s_min_u32 s59, s59, 24
    s_lshl_b32 s59, s59, 10
    s_add_u32 m0, s59, 102400
    v_add_u32 v4, s59, v240
    global_load_lds_dwordx4 v4, s[52:53]
    s_add_u32 s59, s58, 1
    s_min_u32 s59, s59, 24
    s_lshl_b32 s59, s59, 10
    s_add_u32 m0, s59, 102400
    v_add_u32 v4, s59, v240
    global_load_lds_dwordx4 v4, s[52:53]
    s_add_u32 s59, s58, 2
    s_min_u32 s59, s59, 24
    s_lshl_b32 s59, s59, 10
    s_add_u32 m0, s59, 102400
    v_add_u32 v4, s59, v240
    global_load_lds_dwordx4 v4, s[52:53]
    s_add_u32 s59, s58, 3
    s_min_u32 s59, s59, 24
    s_lshl_b32 s59, s59, 10
    s_add_u32 m0, s59, 102400
    v_add_u32 v4, s59, v240
    global_load_lds_dwordx4 v4, s[52:53]
    s_add_u32 s59, s58, 4
    s_min_u32 s59, s59, 24
    s_lshl_b32 s59, s59, 10
    s_add_u32 m0, s59, 102400
    v_add_u32 v4, s59, v240
    global_load_lds_dwordx4 v4, s[52:53]
    s_add_u32 s59, s58, 5
    s_min_u32 s59, s59, 24
    s_lshl_b32 s59, s59, 10
    s_add_u32 m0, s59, 102400
    v_add_u32 v4, s59, v240
    global_load_lds_dwordx4 v4, s[52:53]
    s_add_u32 s59, s58, 6
    s_min_u32 s59, s59, 24
    s_lshl_b32 s59, s59, 10
    s_add_u32 m0, s59, 102400
    v_add_u32 v4, s59, v240
    global_load_lds_dwordx4 v4, s[52:53]
L_nowkv:
    s_setprio 2
    s_mul_i32 s60, s40, 10240
    s_add_u32 s60, s60, 128000
    s_lshl_b32 s58, s70, 11
    s_mul_i32 s59, s70, 3072
    s_add_u32 s59, s59, 4096
    s_cmp_eq_u32 s71, 0
    s_cselect_b32 s61, s58, s59
    s_cselect_b32 s59, s59, s58
    s_add_u32 s61, s61, s60
    s_add_u32 s59, s59, s60
    v_add_u32 v208, s61, v240
    v_add_u32 v209, s59, v240
    s_mul_i32 s60, s40, 29696
    s_sub_u32 s60, 152576, s60
    v_mul_u32_u24 v6, 1280, v3
    v_add_u32 v6, s60, v6
    v_lshl_add_u32 v7, s70, 4, v2
    v_lshl_add_u32 v210, v7, 4, v6
    v_lshl_add_u32 v211, v7, 3, v6
    v_add_u32 v4, s60, v240
    v_and_b32 v5, 31, v1
    v_lshl_add_u32 v5, v5, 3, s60
    s_add_u32 s58, s39, 1
    s_and_b32 s58, s58, 3
    s_mul_i32 s59, s58, 1280
    v_add_u32 v200, s59, v4
    v_add_u32 v204, s59, v5
    s_add_u32 s58, s39, 2
    s_and_b32 s58, s58, 3
    s_mul_i32 s59, s58, 1280
    v_add_u32 v201, s59, v4
    v_add_u32 v205, s59, v5
    v_cndmask_b32 v204, v205, v204, s[76:77]
    s_add_u32 s58, s39, 3
    s_and_b32 s58, s58, 3
    s_mul_i32 s59, s58, 1280
    v_add_u32 v202, s59, v4
    v_add_u32 v206, s59, v5
    s_add_u32 s58, s39, 4
    s_and_b32 s58, s58, 3
    s_mul_i32 s59, s58, 1280
    v_add_u32 v203, s59, v4
    v_add_u32 v207, s59, v5
    v_cndmask_b32 v206, v207, v206, s[76:77]
    s_lshl_b32 s58, s41, 10
    s_add_u32 s58, s58, 36864
    v_and_b32 v212, 7, v1
    v_lshl_add_u32 v212, v212, 7, s58
    v_lshrrev_b32 v213, 3, v1
    v_and_b32 v7, 3, v1
    v_lshl_add_u32 v213, v213, 3, v7
    s_lshl_b32 s58, s39, 13
    s_add_u32 s58, s58, 37376
    v_lshl_add_u32 v213, v213, 7, s58
    v_mov_b32 v214, s72
    v_mov_b32 v215, 1
    s_bitcmp1_b32 s2, 0
    s_cbranch_scc1 L_todd
    s_lshr_b32 s58, s2, 3
    s_lshl_b32 s58, s58, 2
    s_add_u32 s58, s58, s39
    s_and_b32 s59, s2, 6
    v_min_u32 v4, 24, v1
    v_mul_u32_u24 v5, 52, v4
    v_lshrrev_b32 v5, 8, v5
    v_mad_i32_i24 v4, v5, -5, v4
    s_mul_i32 s60, s58, 5
    v_add_u32 v4, s60, v4
    v_mul_u32_u24 v227, 7680, v4
    v_lshl_add_u32 v227, v5, 10, v227
    s_lshl_b32 s60, s59, 7
    s_add_u32 s60, s60, 2560
    v_add_u32 v227, s60, v227
    v_add_u32 v225, 128, v227
    v_min_u32 v4, 20, v1
    v_mul_u32_u24 v5, 37, v4
    v_lshrrev_b32 v5, 8, v5
    v_mad_i32_i24 v4, v5, -7, v4
    s_mul_i32 s60, s58, 14
    s_min_u32 s60, s60, 1714
    v_add_u32 v4, s60, v4
    v_mul_u32_u24 v228, 1280, v4
    s_cmp_lt_u32 s59, 4
    s_cselect_b32 s60, 2, 1
    v_min_u32 v5, s60, v5
    v_lshl_add_u32 v228, v5, 9, v228
    s_lshl_b32 s60, s59, 6
    v_add_u32 v228, s60, v228
    v_add_u32 v226, 8960, v228
    s_branch L_tend
L_todd:
    s_and_b32 s58, s97, 3
    s_lshl_b32 s58, s58, 2
    s_add_u32 s58, s58, s39
    s_mul_i32 s58, s58, 40
    v_min_u32 v227, 19, v1
    v_add_u32 v227, s58, v227
    v_mul_u32_u24 v227, 3456, v227
    s_lshl_b32 s58, s97, 5
    v_add_u32 v227, s58, v227
    s_cmp_lt_u32 s97, 108
    s_cselect_b64 vcc, -1, 0
    v_cndmask_b32 v227, 0, v227, vcc
    v_add_u32 v225, 69120, v227
    v_mov_b32 v228, v227
    v_mov_b32 v226, v225
L_tend:
    s_lshr_b32 s58, s2, 3
    s_lshl_b32 s58, s58, 2
    s_add_u32 s58, s58, s39
    s_mul_i32 s59, s58, 6400
    v_min_u32 v224, 49, v1
    v_lshl_add_u32 v224, v224, 7, s59
    v_min_u32 v229, 9, v1
    v_lshlrev_b32 v229, 7, v229
    s_lshl_b32 s58, s73, 11
    s_lshl_b32 s59, s39, 9
    s_add_u32 s58, s58, s59
    s_add_u32 s58, s58, 2883584
    v_lshl_add_u32 v11, v3, 7, s58
    s_lshl_b32 s58, s41, 2
    s_add_u32 s58, s58, s70
    s_mul_i32 s58, s58, 20480
    s_mul_i32 s59, s42, 2560
    s_add_u32 s58, s58, s59
    s_mul_i32 s59, s71, 1280
    s_add_u32 s58, s58, s59
    s_add_u32 s58, s58, 303104
    v_add_u32 v230, s58, v240
    v_mov_b32 v4, 0x40000000
    v_cndmask_b32 v230, v4, v230, s[76:77]
    s_lshl_b32 s58, s41, 1
    s_add_u32 s58, s58, s70
    s_mul_i32 s59, s58, 1280
    s_mul_i32 s60, s42, 160
    s_add_u32 s59, s59, s60
    s_lshl_b32 s60, s59, 1
    s_add_u32 s59, s59, 3686400
    s_add_u32 s60, s60, 3800928
    v_min_u32 v4, 29, v1
    v_mov_b32 v5, s59
    v_mov_b32 v6, s60
    v_cmp_gt_u32 vcc, 10, v4
    s_lshl_b32 s58, s83, 7
    s_add_u32 s58, s58, 3997696
    v_cndmask_b32 v5, v6, v5, vcc
    v_lshl_add_u32 v5, v4, 4, v5
    v_mov_b32 v6, s58
    s_cmp_lg_u32 s71, 0
    s_cselect_b64 vcc, -1, 0
    v_cndmask_b32 v231, v5, v6, vcc
    s_lshl_b32 s60, s41, 6
    s_lshl_b32 s61, s70, 4
    s_add_u32 s60, s60, s61
    s_add_u32 s60, s60, 32
    v_add_u32 v216, s60, v2
    v_mul_u32_u24 v216, 1280, v216
    s_mul_i32 s60, s42, 160
    s_mul_i32 s61, s71, 24
    s_add_u32 s60, s60, s61
    v_mad_u32_u24 v217, v3, 40, s60
    v_add_u32 v216, v217, v216
    s_lshl_b32 s61, s71, 4
    v_subrev_u32 v218, s61, v216
    v_min_u32 v219, 19, v1
    s_mul_i32 s58, s39, 5120
    s_add_u32 s58, s58, 14340
    v_lshl_add_u32 v219, v219, 8, s58
    v_lshrrev_b32 v4, 3, v1
    v_and_b32 v4, 3, v4
    v_lshl_add_u32 v4, v4, 2, v212
    v_add_u32 v4, 32768, v4
    v_cndmask_b32 v219, v4, v219, s[76:77]
    s_lshl_b32 s58, s73, 7
    s_lshl_b32 s59, s39, 2
    s_add_u32 s58, s58, s59
    s_add_u32 s58, s58, 69632
    v_mov_b32 v237, s58
    v_mul_u32_u24 v220, 80, v3
    s_mul_i32 s58, s71, 48
    s_add_u32 s58, s58, 160512
    v_add_u32 v220, s58, v220
    s_lshl_b32 s60, s41, 14
    s_lshl_b32 s61, s70, 12
    s_add_u32 s60, s60, s61
    s_lshl_b32 s61, s42, 9
    s_add_u32 s60, s60, s61
    s_lshl_b32 s61, s71, 8
    s_add_u32 s60, s60, s61
    s_add_u32 s88, s60, 3153920
    s_lshl_b32 s59, s41, 2
    s_add_u32 s59, s59, s70
    s_mul_i32 s60, s59, 20480
    s_mul_i32 s61, s71, 10240
    s_add_u32 s60, s60, s61
    s_add_u32 s60, s60, 528384
    s_add_u32 s98, s36, s60
    s_addc_u32 s99, s37, 0
    s_add_u32 s100, s98, 0x2000
    s_addc_u32 s101, s99, 0
    s_lshl_b32 s62, s70, 2
    s_add_u32 s62, s62, 160276
    s_cmp_ge_u32 s97, 108
    s_cbranch_scc1 L_fd2
    s_mov_b32 s66, 10
    s_mov_b32 s64, 3456
    s_cmp_eq_u32 s71, 0
    s_cselect_b64 s[34:35], s[22:23], s[24:25]
    s_mul_i32 s58, s70, 1105920
    s_lshl_b32 s59, s97, 5
    s_add_u32 s58, s58, s59
    s_mul_i32 s59, s70, 10240
    s_branch L_fde
L_fd2:
    s_cmp_lt_u32 s97, 148
    s_cselect_b32 s66, 14, 0
    s_mov_b32 s64, 1280
    s_mov_b64 s[34:35], s[26:27]
    s_mul_i32 s58, s39, 14
    s_min_u32 s58, s58, 40
    s_mul_i32 s58, s58, 40960
    s_sub_u32 s59, s97, 108
    s_lshl_b32 s59, s59, 5
    s_add_u32 s58, s58, s59
    s_mul_i32 s59, s70, 14336
L_fde:
    s_add_u32 s34, s34, s58
    s_addc_u32 s35, s35, 0
    s_lshl_b32 s67, s64, 5
    s_mul_i32 s65, s71, 51200
    s_add_u32 s65, s65, s59
    s_setprio 3
    s_waitcnt lgkmcnt(0)
    s_mul_i32 s43, s43, 1664525
    s_add_u32 s43, s43, 1013904223
    v_mov_b32 v238, s43
    s_cmp_lt_u32 s46, 80
    s_cbranch_scc1 L_cw
    s_waitcnt vmcnt(0)
L_cw:
    s_waitcnt vmcnt(5)
    v_lshlrev_b32 v56, 16, v100
    v_and_b32 v57, 0xffff0000, v100
    v_lshlrev_b32 v58, 16, v101
    v_and_b32 v59, 0xffff0000, v101
    v_mul_f32 v60, 0xbfb8aa3b, v56
    v_mul_f32 v61, 0xbfb8aa3b, v57
    v_mul_f32 v62, 0xbfb8aa3b, v58
    v_mul_f32 v63, 0xbfb8aa3b, v59
    v_exp_f32 v60, v60
    v_exp_f32 v61, v61
    v_exp_f32 v62, v62
    v_exp_f32 v63, v63
    v_add_f32 v60, 1.0, v60
    v_add_f32 v61, 1.0, v61
    v_add_f32 v62, 1.0, v62
    v_add_f32 v63, 1.0, v63
    v_rcp_f32 v60, v60
    v_rcp_f32 v61, v61
    v_rcp_f32 v62, v62
    v_rcp_f32 v63, v63
    v_mul_f32 v60, v56, v60
    v_mul_f32 v61, v57, v61
    v_mul_f32 v62, v58, v62
    v_mul_f32 v63, v59, v63
    v_cvt_pk_bf16_f32 v100, v60, v61
    v_cvt_pk_bf16_f32 v101, v62, v63
    v_add_u32 v102, 157696, v102
    ds_write_b64 v102, v[100:101]
    s_cmp_ge_u32 s46, 80
    s_cbranch_scc1 L_xw
    s_mul_i32 s58, s39, 320
    s_add_u32 s58, s58, 157696
    v_lshl_add_u32 v4, v3, 4, s58
    v_lshlrev_b32 v5, 8, v3
    v_lshl_add_u32 v5, v2, 3, v5
    s_mul_i32 s58, s39, 5120
    s_add_u32 s58, s58, 102400
    v_add_u32 v5, s58, v5
    s_waitcnt lgkmcnt(0)
    ds_read_b128 v[56:59], v4 offset:0
    ds_read_b128 v[60:63], v4 offset:64
    ds_read_b128 v[64:67], v4 offset:128
    ds_read_b128 v[68:71], v4 offset:192
    ds_read_b128 v[72:75], v4 offset:256
    s_waitcnt vmcnt(0)
    ds_read_b64_tr_b16 v[76:77], v5 offset:0
    ds_read_b64_tr_b16 v[78:79], v5 offset:128
    ds_read_b64_tr_b16 v[80:81], v5 offset:1024
    ds_read_b64_tr_b16 v[82:83], v5 offset:1152
    ds_read_b64_tr_b16 v[84:85], v5 offset:2048
    ds_read_b64_tr_b16 v[86:87], v5 offset:2176
    ds_read_b64_tr_b16 v[88:89], v5 offset:3072
    ds_read_b64_tr_b16 v[90:91], v5 offset:3200
    ds_read_b64_tr_b16 v[92:93], v5 offset:4096
    ds_read_b64_tr_b16 v[94:95], v5 offset:4224
    s_waitcnt lgkmcnt(8)
    v_mfma_f32_16x16x32_bf16 v[96:99], v[76:79], v[56:59], 0
    s_waitcnt lgkmcnt(6)
    v_mfma_f32_16x16x32_bf16 v[96:99], v[80:83], v[60:63], v[96:99]
    s_waitcnt lgkmcnt(4)
    v_mfma_f32_16x16x32_bf16 v[96:99], v[84:87], v[64:67], v[96:99]
    s_waitcnt lgkmcnt(2)
    v_mfma_f32_16x16x32_bf16 v[96:99], v[88:91], v[68:71], v[96:99]
    s_waitcnt lgkmcnt(0)
    v_mfma_f32_16x16x32_bf16 v[96:99], v[92:95], v[72:75], v[96:99]
    s_lshl_b32 s58, s39, 6
    s_add_u32 s58, s58, 158976
    v_lshl_add_u32 v6, v3, 4, s58
    s_cmp_eq_u32 s39, 0
    s_cbranch_scc1 L_mf_1
    s_nop 2
    ds_write_b128 v6, v[96:99]
    v_mov_b32 v4, 160256
    v_mov_b32 v5, 1
    s_mov_b64 exec, 1
    ds_add_u32 v4, v5
    s_mov_b64 exec, -1
    s_branch L_xw
L_mf_1:
    v_mov_b32 v4, 160256
    s_lshl_b32 s58, s82, 7
    s_add_u32 s58, s58, 4096
    v_lshl_add_u32 v7, v3, 4, s58
    v_lshl_add_u32 v7, v2, 6, v7
    v_mov_b32 v69, s43
    v_mov_b32 v71, s43
    s_mov_b32 s47, 1048576
L_lw_2:
    ds_read_b32 v5, v4
    s_waitcnt lgkmcnt(0)
    v_readfirstlane_b32 s63, v5
    s_nop 0
    s_cmp_ge_u32 s63, 3
    s_cbranch_scc1 L_lwr_3
    s_sub_u32 s47, s47, 1
    s_cbranch_scc0 L_lw_2
L_lwr_3:
    ds_read_b128 v[56:59], v6 offset:64
    ds_read_b128 v[60:63], v6 offset:128
    ds_read_b128 v[64:67], v6 offset:192
L_lwe_4:
    s_mov_b32 s52, 0x00030003
    s_mov_b32 s53, 0x00030003
    s_sub_u32 s58, s82, 40
    s_cmp_lt_u32 s58, 40
    s_waitcnt lgkmcnt(0)
    v_pk_add_f32 v[96:97], v[96:97], v[56:57]
    v_pk_add_f32 v[98:99], v[98:99], v[58:59]
    v_pk_add_f32 v[60:61], v[60:61], v[64:65]
    v_pk_add_f32 v[62:63], v[62:63], v[66:67]
    v_pk_add_f32 v[96:97], v[96:97], v[60:61]
    v_pk_add_f32 v[98:99], v[98:99], v[62:63]
    v_cvt_pk_bf16_f32 v68, v96, v97
    v_cvt_pk_bf16_f32 v70, v98, v99
    s_cbranch_scc0 L_mf_1_s
    v_lshlrev_b32 v96, 16, v68
    v_and_b32 v97, 0xffff0000, v68
    v_lshlrev_b32 v98, 16, v70
    v_and_b32 v99, 0xffff0000, v70
    v_pk_add_f32 v[96:97], v[96:97], 1.0 op_sel_hi:[1,0]
    v_pk_add_f32 v[98:99], v[98:99], 1.0 op_sel_hi:[1,0]
    v_cvt_pk_bf16_f32 v68, v96, v97
    v_cvt_pk_bf16_f32 v70, v98, v99
L_mf_1_s:
    s_mov_b64 exec, s[52:53]
    global_store_dwordx4 v7, v[68:71], s[36:37] sc1
    s_mov_b64 exec, -1
L_xw:
    s_barrier
    s_branch L_ln
L_xQ:
    s_mul_i32 s60, s39, 10240
    s_add_u32 m0, s60, 0
    s_nop 0
    global_load_lds_dwordx4 v106, s[8:9] offset:0
    s_add_u32 m0, s60, 40960
    s_nop 0
    global_load_lds_dwordx4 v107, s[8:9] offset:0
    s_waitcnt vmcnt(8)
    s_add_u32 m0, s60, 960
    s_nop 0
    global_load_lds_dwordx4 v106, s[8:9] offset:64
    s_add_u32 m0, s60, 41920
    s_nop 0
    global_load_lds_dwordx4 v107, s[8:9] offset:64
    s_waitcnt vmcnt(8)
    s_add_u32 m0, s60, 1920
    s_nop 0
    global_load_lds_dwordx4 v106, s[8:9] offset:128
    s_add_u32 m0, s60, 42880
    s_nop 0
    global_load_lds_dwordx4 v107, s[8:9] offset:128
    s_waitcnt vmcnt(8)
    s_add_u32 m0, s60, 2880
    s_nop 0
    global_load_lds_dwordx4 v106, s[8:9] offset:192
    s_add_u32 m0, s60, 43840
    s_nop 0
    global_load_lds_dwordx4 v107, s[8:9] offset:192
    s_waitcnt vmcnt(8)
    s_add_u32 m0, s60, 3840
    s_nop 0
    global_load_lds_dwordx4 v106, s[8:9] offset:256
    s_add_u32 m0, s60, 44800
    s_nop 0
    global_load_lds_dwordx4 v107, s[8:9] offset:256
    s_waitcnt vmcnt(8)
    s_add_u32 m0, s60, 4800
    s_nop 0
    global_load_lds_dwordx4 v106, s[8:9] offset:320
    s_add_u32 m0, s60, 45760
    s_nop 0
    global_load_lds_dwordx4 v107, s[8:9] offset:320
    s_waitcnt vmcnt(8)
    s_add_u32 m0, s60, 5760
    s_nop 0
    global_load_lds_dwordx4 v106, s[8:9] offset:384
    s_add_u32 m0, s60, 46720
    s_nop 0
    global_load_lds_dwordx4 v107, s[8:9] offset:384
    s_waitcnt vmcnt(8)
    s_add_u32 m0, s60, 6720
    s_nop 0
    global_load_lds_dwordx4 v106, s[8:9] offset:448
    s_add_u32 m0, s60, 47680
    s_nop 0
    global_load_lds_dwordx4 v107, s[8:9] offset:448
    s_waitcnt vmcnt(8)
    s_add_u32 m0, s60, 7680
    s_nop 0
    global_load_lds_dwordx4 v106, s[8:9] offset:512
    s_add_u32 m0, s60, 48640
    s_nop 0
    global_load_lds_dwordx4 v107, s[8:9] offset:512
    s_waitcnt vmcnt(8)
    s_add_u32 m0, s60, 8640
    s_nop 0
    global_load_lds_dwordx4 v106, s[8:9] offset:576
    s_add_u32 m0, s60, 49600
    s_nop 0
    global_load_lds_dwordx4 v107, s[8:9] offset:576
    s_waitcnt vmcnt(8)
    s_mul_i32 s60, s40, 10240
    s_add_u32 s60, s60, 128000
    s_lshl_b32 s58, s70, 11
    s_mul_i32 s59, s70, 3072
    s_add_u32 s59, s59, 4096
    s_cmp_eq_u32 s71, 0
    s_cselect_b32 s61, s58, s59
    s_cselect_b32 s59, s59, s58
    s_add_u32 s61, s61, s60
    s_add_u32 s59, s59, s60
    v_add_u32 v208, s61, v240
    v_add_u32 v209, s59, v240
    s_mul_i32 s60, s40, 29696
    s_sub_u32 s60, 152576, s60
    v_mul_u32_u24 v6, 1280, v3
    v_add_u32 v6, s60, v6
    v_lshl_add_u32 v7, s70, 4, v2
    v_lshl_add_u32 v210, v7, 4, v6
    v_lshl_add_u32 v211, v7, 3, v6
    v_add_u32 v4, s60, v240
    v_and_b32 v5, 31, v1
    v_lshl_add_u32 v5, v5, 3, s60
    s_add_u32 s58, s39, 1
    s_and_b32 s58, s58, 3
    s_mul_i32 s59, s58, 1280
    v_add_u32 v200, s59, v4
    v_add_u32 v204, s59, v5
    s_add_u32 s58, s39, 2
    s_and_b32 s58, s58, 3
    s_mul_i32 s59, s58, 1280
    v_add_u32 v201, s59, v4
    v_add_u32 v205, s59, v5
    v_cndmask_b32 v204, v205, v204, s[76:77]
    s_add_u32 s58, s39, 3
    s_and_b32 s58, s58, 3
    s_mul_i32 s59, s58, 1280
    v_add_u32 v202, s59, v4
    v_add_u32 v206, s59, v5
    s_add_u32 s58, s39, 4
    s_and_b32 s58, s58, 3
    s_mul_i32 s59, s58, 1280
    v_add_u32 v203, s59, v4
    v_add_u32 v207, s59, v5
    v_cndmask_b32 v206, v207, v206, s[76:77]
    s_lshl_b32 s58, s41, 10
    s_add_u32 s58, s58, 36864
    v_and_b32 v212, 7, v1
    v_lshl_add_u32 v212, v212, 7, s58
    v_lshrrev_b32 v213, 3, v1
    v_and_b32 v7, 3, v1
    v_lshl_add_u32 v213, v213, 3, v7
    s_lshl_b32 s58, s39, 13
    s_add_u32 s58, s58, 37376
    v_lshl_add_u32 v213, v213, 7, s58
    v_mov_b32 v214, s72
    v_mov_b32 v215, 1
    s_lshl_b32 s60, s41, 6
    s_lshl_b32 s61, s70, 4
    s_add_u32 s60, s60, s61
    s_add_u32 s60, s60, 0
    v_add_u32 v230, s60, v2
    v_mul_u32_u24 v230, 1280, v230
    s_mul_i32 s60, s42, 160
    s_mul_i32 s61, s71, 24
    s_add_u32 s60, s60, s61
    v_mad_u32_u24 v231, v3, 40, s60
    v_add_u32 v230, v231, v230
    v_lshrrev_b32 v224, 1, v1
    v_lshlrev_b32 v224, 10, v224
    v_add_u32 v224, 36864, v224
    s_lshl_b32 s61, s71, 4
    v_subrev_u32 v225, s61, v230
    v_mov_b64 v[226:227], 0
    v_mov_b64 v[228:229], 0
    v_mov_b64 v[216:217], 0
    v_mov_b64 v[218:219], 0
    s_mov_b64 s[98:99], s[36:37]
    s_mov_b64 s[100:101], s[36:37]
    s_waitcnt lgkmcnt(0)
    s_mul_i32 s43, s43, 1664525
    s_add_u32 s43, s43, 1013904223
    v_mov_b32 v238, s43
    s_waitcnt vmcnt(0)
    s_barrier
    s_lshr_b32 s58, s42, 2
    s_lshl_b32 s58, s58, 7
    v_add_u32 v108, s58, v108
    global_load_dword v190, v108, s[10:11]
    global_load_dword v191, v109, s[36:37] sc1
L_ln:
    ds_read_b128 v[16:19], v184 offset:0
    ds_read_b128 v[20:23], v184 offset:1024
    ds_read_b128 v[24:27], v184 offset:2048
    ds_read_b128 v[28:31], v184 offset:3072
    ds_read_b128 v[32:35], v184 offset:4096
    ds_read_b128 v[36:39], v184 offset:5120
    ds_read_b128 v[40:43], v184 offset:6144
    ds_read_b128 v[44:47], v184 offset:7168
    ds_read_b128 v[48:51], v184 offset:8192
    ds_read_b128 v[52:55], v184 offset:9216
    s_waitcnt lgkmcnt(9)
    v_mfma_f32_16x16x32_bf16 v[140:143], v[136:139], v[16:19], 0
    v_mfma_f32_16x16x32_bf16 v[144:147], v[16:19], v[16:19], 0
    v_lshlrev_b32 v56, 16, v16
    v_and_b32 v57, 0xffff0000, v16
    s_waitcnt lgkmcnt(8)
    v_mfma_f32_16x16x32_bf16 v[140:143], v[136:139], v[20:23], v[140:143]
    v_mfma_f32_16x16x32_bf16 v[144:147], v[20:23], v[20:23], v[144:147]
    v_lshlrev_b32 v64, 16, v20
    v_and_b32 v65, 0xffff0000, v20
    s_waitcnt lgkmcnt(7)
    v_mfma_f32_16x16x32_bf16 v[140:143], v[136:139], v[24:27], v[140:143]
    v_mfma_f32_16x16x32_bf16 v[144:147], v[24:27], v[24:27], v[144:147]
    v_lshlrev_b32 v72, 16, v24
    v_and_b32 v73, 0xffff0000, v24
    s_waitcnt lgkmcnt(6)
    v_mfma_f32_16x16x32_bf16 v[140:143], v[136:139], v[28:31], v[140:143]
    v_mfma_f32_16x16x32_bf16 v[144:147], v[28:31], v[28:31], v[144:147]
    v_lshlrev_b32 v80, 16, v28
    v_and_b32 v81, 0xffff0000, v28
    s_waitcnt lgkmcnt(5)
    v_mfma_f32_16x16x32_bf16 v[140:143], v[136:139], v[32:35], v[140:143]
    v_mfma_f32_16x16x32_bf16 v[144:147], v[32:35], v[32:35], v[144:147]
    v_lshlrev_b32 v88, 16, v32
    v_and_b32 v89, 0xffff0000, v32
    s_waitcnt lgkmcnt(4)
    v_mfma_f32_16x16x32_bf16 v[140:143], v[136:139], v[36:39], v[140:143]
    v_mfma_f32_16x16x32_bf16 v[144:147], v[36:39], v[36:39], v[144:147]
    v_lshlrev_b32 v96, 16, v36
    v_and_b32 v97, 0xffff0000, v36
    s_waitcnt lgkmcnt(3)
    v_mfma_f32_16x16x32_bf16 v[140:143], v[136:139], v[40:43], v[140:143]
    v_mfma_f32_16x16x32_bf16 v[144:147], v[40:43], v[40:43], v[144:147]
    v_lshlrev_b32 v104, 16, v40
    v_and_b32 v105, 0xffff0000, v40
    s_waitcnt lgkmcnt(2)
    v_mfma_f32_16x16x32_bf16 v[140:143], v[136:139], v[44:47], v[140:143]
    v_mfma_f32_16x16x32_bf16 v[144:147], v[44:47], v[44:47], v[144:147]
    v_lshlrev_b32 v112, 16, v44
    v_and_b32 v113, 0xffff0000, v44
    s_waitcnt lgkmcnt(1)
    v_mfma_f32_16x16x32_bf16 v[140:143], v[136:139], v[48:51], v[140:143]
    v_mfma_f32_16x16x32_bf16 v[144:147], v[48:51], v[48:51], v[144:147]
    v_lshlrev_b32 v120, 16, v48
    v_and_b32 v121, 0xffff0000, v48
    s_waitcnt lgkmcnt(0)
    v_mfma_f32_16x16x32_bf16 v[140:143], v[136:139], v[52:55], v[140:143]
    v_mfma_f32_16x16x32_bf16 v[144:147], v[52:55], v[52:55], v[144:147]
    v_lshlrev_b32 v128, 16, v52
    v_and_b32 v129, 0xffff0000, v52
    v_lshlrev_b32 v58, 16, v17
    v_and_b32 v59, 0xffff0000, v17
    v_lshlrev_b32 v66, 16, v21
    v_and_b32 v67, 0xffff0000, v21
    v_lshlrev_b32 v74, 16, v25
    v_and_b32 v75, 0xffff0000, v25
    v_cndmask_b32 v141, v144, v145, s[86:87]
    v_cndmask_b32 v141, v141, v146, s[54:55]
    v_cndmask_b32 v141, v141, v147, s[56:57]
    s_mov_b64 exec, s[84:85]
    ds_write_b64 v185, v[140:141]
    s_mov_b64 exec, -1
    s_add_u32 s45, s45, 4
    v_mov_b32 v142, s72
    v_mov_b32 v143, 1
    s_mov_b64 exec, 1
    ds_add_u32 v142, v143
    s_mov_b64 exec, -1
    v_lshlrev_b32 v82, 16, v29
    v_and_b32 v83, 0xffff0000, v29
    v_lshlrev_b32 v90, 16, v33
    v_and_b32 v91, 0xffff0000, v33
    v_lshlrev_b32 v98, 16, v37
    v_and_b32 v99, 0xffff0000, v37
    v_lshlrev_b32 v106, 16, v41
    v_and_b32 v107, 0xffff0000, v41
    v_lshlrev_b32 v114, 16, v45
    v_and_b32 v115, 0xffff0000, v45
    v_lshlrev_b32 v122, 16, v49
    v_and_b32 v123, 0xffff0000, v49
    v_lshlrev_b32 v130, 16, v53
    v_and_b32 v131, 0xffff0000, v53
    v_lshlrev_b32 v60, 16, v18
    v_and_b32 v61, 0xffff0000, v18
    v_lshlrev_b32 v68, 16, v22
    v_and_b32 v69, 0xffff0000, v22
    v_lshlrev_b32 v76, 16, v26
    v_and_b32 v77, 0xffff0000, v26
    v_lshlrev_b32 v84, 16, v30
    v_and_b32 v85, 0xffff0000, v30
    v_lshlrev_b32 v92, 16, v34
    v_and_b32 v93, 0xffff0000, v34
    v_lshlrev_b32 v100, 16, v38
    v_and_b32 v101, 0xffff0000, v38
    s_mov_b32 s47, 1048576
L_lw_5:
    ds_read_b32 v143, v142
    s_waitcnt lgkmcnt(0)
    v_readfirstlane_b32 s63, v143
    s_nop 0
    s_cmp_ge_u32 s63, s45
    s_cbranch_scc1 L_lwr_6
    s_sub_u32 s47, s47, 1
    s_cbranch_scc0 L_lw_5
L_lwr_6:
    ds_read_b64 v[4:5], v186
    ds_read_b64 v[6:7], v186 offset:256
L_lwe_7:
    v_lshlrev_b32 v108, 16, v42
    v_and_b32 v109, 0xffff0000, v42
    v_lshlrev_b32 v116, 16, v46
    v_and_b32 v117, 0xffff0000, v46
    v_lshlrev_b32 v124, 16, v50
    v_and_b32 v125, 0xffff0000, v50
    v_lshlrev_b32 v132, 16, v54
    v_and_b32 v133, 0xffff0000, v54
    v_lshlrev_b32 v62, 16, v19
    v_and_b32 v63, 0xffff0000, v19
    v_lshlrev_b32 v70, 16, v23
    v_and_b32 v71, 0xffff0000, v23
    v_lshlrev_b32 v78, 16, v27
    v_and_b32 v79, 0xffff0000, v27
    v_lshlrev_b32 v86, 16, v31
    v_and_b32 v87, 0xffff0000, v31
    v_lshlrev_b32 v94, 16, v35
    v_and_b32 v95, 0xffff0000, v35
    v_lshlrev_b32 v102, 16, v39
    v_and_b32 v103, 0xffff0000, v39
    v_lshlrev_b32 v110, 16, v43
    v_and_b32 v111, 0xffff0000, v43
    v_lshlrev_b32 v118, 16, v47
    v_and_b32 v119, 0xffff0000, v47
    v_lshlrev_b32 v126, 16, v51
    v_and_b32 v127, 0xffff0000, v51
    v_lshlrev_b32 v134, 16, v55
    v_and_b32 v135, 0xffff0000, v55
    s_waitcnt lgkmcnt(0)
    v_pk_add_f32 v[4:5], v[4:5], v[6:7]
    v_mul_f32 v4, 0xbacccccd, v4
    v_mul_f32 v5, 0x3acccccd, v5
    v_fma_f32 v5, -v4, v4, v5
    v_max_f32 v5, 0, v5
    v_add_f32 v5, 0x3727c5ac, v5
    v_rsq_f32 v6, v5
    s_lshl_b32 s61, s38, 1
    v_mul_f32 v4, v4, v6
    s_mul_i32 s58, s61, 40960
    s_mul_i32 s59, s42, 160
    s_add_u32 s58, s58, s59
    s_add_u32 s84, s10, s58
    s_addc_u32 s85, s11, 0
    s_mul_i32 s68, s61, 5120
    s_add_u32 s86, s84, 40960
    s_addc_u32 s87, s85, 0
    ds_read_b64_tr_b16 v[144:145], v187 offset:0
    ds_read_b64_tr_b16 v[146:147], v187 offset:160
    v_pk_fma_f32 v[56:57], v[56:57], v[6:7], v[4:5] op_sel_hi:[1,0,0]
    v_pk_fma_f32 v[58:59], v[58:59], v[6:7], v[4:5] op_sel_hi:[1,0,0]
    v_pk_fma_f32 v[60:61], v[60:61], v[6:7], v[4:5] op_sel_hi:[1,0,0]
    v_pk_fma_f32 v[62:63], v[62:63], v[6:7], v[4:5] op_sel_hi:[1,0,0]
    ds_read_b64_tr_b16 v[148:149], v187 offset:1280
    ds_read_b64_tr_b16 v[150:151], v187 offset:1440
    v_pk_fma_f32 v[64:65], v[64:65], v[6:7], v[4:5] op_sel_hi:[1,0,0]
    v_pk_fma_f32 v[66:67], v[66:67], v[6:7], v[4:5] op_sel_hi:[1,0,0]
    v_pk_fma_f32 v[68:69], v[68:69], v[6:7], v[4:5] op_sel_hi:[1,0,0]
    v_pk_fma_f32 v[70:71], v[70:71], v[6:7], v[4:5] op_sel_hi:[1,0,0]
    ds_read_b64_tr_b16 v[152:153], v187 offset:2560
    ds_read_b64_tr_b16 v[154:155], v187 offset:2720
    v_pk_fma_f32 v[72:73], v[72:73], v[6:7], v[4:5] op_sel_hi:[1,0,0]
    v_pk_fma_f32 v[74:75], v[74:75], v[6:7], v[4:5] op_sel_hi:[1,0,0]
    v_pk_fma_f32 v[76:77], v[76:77], v[6:7], v[4:5] op_sel_hi:[1,0,0]
    v_pk_fma_f32 v[78:79], v[78:79], v[6:7], v[4:5] op_sel_hi:[1,0,0]
    ds_read_b64_tr_b16 v[156:157], v187 offset:3840
    ds_read_b64_tr_b16 v[158:159], v187 offset:4000
    v_pk_fma_f32 v[80:81], v[80:81], v[6:7], v[4:5] op_sel_hi:[1,0,0]
    v_pk_fma_f32 v[82:83], v[82:83], v[6:7], v[4:5] op_sel_hi:[1,0,0]
    v_pk_fma_f32 v[84:85], v[84:85], v[6:7], v[4:5] op_sel_hi:[1,0,0]
    v_pk_fma_f32 v[86:87], v[86:87], v[6:7], v[4:5] op_sel_hi:[1,0,0]
    ds_read_b64_tr_b16 v[160:161], v187 offset:5120
    ds_read_b64_tr_b16 v[162:163], v187 offset:5280
    v_pk_fma_f32 v[88:89], v[88:89], v[6:7], v[4:5] op_sel_hi:[1,0,0]
    v_pk_fma_f32 v[90:91], v[90:91], v[6:7], v[4:5] op_sel_hi:[1,0,0]
    v_pk_fma_f32 v[92:93], v[92:93], v[6:7], v[4:5] op_sel_hi:[1,0,0]
    v_pk_fma_f32 v[94:95], v[94:95], v[6:7], v[4:5] op_sel_hi:[1,0,0]
    ds_read_b64_tr_b16 v[164:165], v187 offset:6400
    ds_read_b64_tr_b16 v[166:167], v187 offset:6560
    v_pk_fma_f32 v[96:97], v[96:97], v[6:7], v[4:5] op_sel_hi:[1,0,0]
    v_pk_fma_f32 v[98:99], v[98:99], v[6:7], v[4:5] op_sel_hi:[1,0,0]
    v_pk_fma_f32 v[100:101], v[100:101], v[6:7], v[4:5] op_sel_hi:[1,0,0]
    v_pk_fma_f32 v[102:103], v[102:103], v[6:7], v[4:5] op_sel_hi:[1,0,0]
    ds_read_b64_tr_b16 v[168:169], v187 offset:7680
    ds_read_b64_tr_b16 v[170:171], v187 offset:7840
    v_pk_fma_f32 v[104:105], v[104:105], v[6:7], v[4:5] op_sel_hi:[1,0,0]
    v_pk_fma_f32 v[106:107], v[106:107], v[6:7], v[4:5] op_sel_hi:[1,0,0]
    v_pk_fma_f32 v[108:109], v[108:109], v[6:7], v[4:5] op_sel_hi:[1,0,0]
    v_pk_fma_f32 v[110:111], v[110:111], v[6:7], v[4:5] op_sel_hi:[1,0,0]
    ds_read_b64_tr_b16 v[172:173], v187 offset:8960
    ds_read_b64_tr_b16 v[174:175], v187 offset:9120
    v_pk_fma_f32 v[112:113], v[112:113], v[6:7], v[4:5] op_sel_hi:[1,0,0]
    v_pk_fma_f32 v[114:115], v[114:115], v[6:7], v[4:5] op_sel_hi:[1,0,0]
    v_pk_fma_f32 v[116:117], v[116:117], v[6:7], v[4:5] op_sel_hi:[1,0,0]
    v_pk_fma_f32 v[118:119], v[118:119], v[6:7], v[4:5] op_sel_hi:[1,0,0]
    ds_read_b64_tr_b16 v[176:177], v187 offset:10240
    ds_read_b64_tr_b16 v[178:179], v187 offset:10400
    v_pk_fma_f32 v[120:121], v[120:121], v[6:7], v[4:5] op_sel_hi:[1,0,0]
    v_pk_fma_f32 v[122:123], v[122:123], v[6:7], v[4:5] op_sel_hi:[1,0,0]
    v_pk_fma_f32 v[124:125], v[124:125], v[6:7], v[4:5] op_sel_hi:[1,0,0]
    v_pk_fma_f32 v[126:127], v[126:127], v[6:7], v[4:5] op_sel_hi:[1,0,0]
    ds_read_b64_tr_b16 v[180:181], v187 offset:11520
    ds_read_b64_tr_b16 v[182:183], v187 offset:11680
    v_pk_fma_f32 v[128:129], v[128:129], v[6:7], v[4:5] op_sel_hi:[1,0,0]
    v_pk_fma_f32 v[130:131], v[130:131], v[6:7], v[4:5] op_sel_hi:[1,0,0]
    v_pk_fma_f32 v[132:133], v[132:133], v[6:7], v[4:5] op_sel_hi:[1,0,0]
    v_pk_fma_f32 v[134:135], v[134:135], v[6:7], v[4:5] op_sel_hi:[1,0,0]
    s_cmp_lg_u32 s40, 0
    s_cbranch_scc1 L_preB
    s_add_u32 m0, s68, 0
    s_nop 0
    global_load_lds_dwordx4 v232, s[84:85]
    s_add_u32 m0, s68, 1024
    s_nop 0
    global_load_lds_dwordx4 v233, s[84:85]
    s_add_u32 m0, s68, 2048
    s_nop 0
    global_load_lds_dwordx4 v234, s[84:85]
    s_add_u32 m0, s68, 3072
    s_nop 0
    global_load_lds_dwordx4 v235, s[84:85]
    s_add_u32 m0, s68, 4096
    s_nop 0
    global_load_lds_dwordx4 v236, s[84:85]
    s_mov_b32 s47, 131072
L_mp:
    global_load_dwordx4 v[16:19], v14, s[36:37] sc1
    global_load_dwordx4 v[20:23], v14, s[36:37] offset:16 sc1
    s_waitcnt vmcnt(0)
L_mp1:
    v_min3_u32 v24, v17, v19, v21
    v_max3_u32 v25, v17, v19, v21
    v_xor_b32 v24, s43, v24
    v_xor_b32 v25, s43, v25
    v_xor_b32 v26, s43, v23
    v_or3_b32 v24, v24, v25, v26
    v_cmp_ne_u32 vcc, 0, v24
    s_nop 0
    s_cbranch_vccz L_mpe
    s_mov_b64 exec, vcc
    s_sub_u32 s47, s47, 1
    s_cbranch_scc0 L_mp
L_mpe:
    s_mov_b64 exec, -1
    v_lshlrev_b32 v24, 16, v16
    v_and_b32 v25, 0xffff0000, v16
    v_lshlrev_b32 v26, 16, v18
    v_and_b32 v27, 0xffff0000, v18
    ds_write_b128 v15, v[24:27]
    v_lshlrev_b32 v28, 16, v20
    v_and_b32 v29, 0xffff0000, v20
    v_lshlrev_b32 v30, 16, v22
    v_and_b32 v31, 0xffff0000, v22
    ds_write_b128 v15, v[28:31] offset:16
    v_mov_b32 v4, 160308
    v_mov_b32 v5, 1
    s_mov_b64 exec, 1
    ds_add_u32 v4, v5
    s_mov_b64 exec, -1
    s_branch L_modok
L_preB:
    s_add_u32 s61, s39, 16
    s_mul_i32 s58, s61, 40960
    s_mul_i32 s59, s42, 160
    s_add_u32 s58, s58, s59
    s_add_u32 s52, s10, s58
    s_addc_u32 s53, s11, 0
    s_mul_i32 s60, s61, 5120
    s_waitcnt vmcnt(0)
    s_add_u32 m0, s60, 0
    s_nop 0
    global_load_lds_dwordx4 v232, s[52:53]
    s_add_u32 m0, s60, 1024
    s_nop 0
    global_load_lds_dwordx4 v233, s[52:53]
    s_add_u32 m0, s60, 2048
    s_nop 0
    global_load_lds_dwordx4 v234, s[52:53]
    s_add_u32 m0, s60, 3072
    s_nop 0
    global_load_lds_dwordx4 v235, s[52:53]
    s_add_u32 m0, s60, 4096
    s_nop 0
    global_load_lds_dwordx4 v236, s[52:53]
    s_add_u32 m0, s68, 0
    s_nop 0
    global_load_lds_dwordx4 v232, s[84:85]
    s_add_u32 m0, s68, 1024
    s_nop 0
    global_load_lds_dwordx4 v233, s[84:85]
    s_add_u32 m0, s68, 2048
    s_nop 0
    global_load_lds_dwordx4 v234, s[84:85]
    s_add_u32 m0, s68, 3072
    s_nop 0
    global_load_lds_dwordx4 v235, s[84:85]
    s_add_u32 m0, s68, 4096
    s_nop 0
    global_load_lds_dwordx4 v236, s[84:85]
    v_mov_b32 v4, 160308
L_modok:
    s_mov_b32 s47, 1048576
L_lw_8:
    ds_read_b32 v5, v4
    s_waitcnt lgkmcnt(0)
    v_readfirstlane_b32 s63, v5
    s_nop 0
    s_cmp_ge_u32 s63, 4
    s_cbranch_scc1 L_lwr_9
    s_sub_u32 s47, s47, 1
    s_cbranch_scc0 L_lw_8
L_lwr_9:
    ds_read_b128 v[16:19], v10 offset:2560
    ds_read_b128 v[24:27], v10 offset:0
    ds_read_b128 v[20:23], v10 offset:2576
    ds_read_b128 v[28:31], v10 offset:16
    ds_read_b128 v[32:35], v10 offset:2688
    ds_read_b128 v[40:43], v10 offset:128
    ds_read_b128 v[36:39], v10 offset:2704
    ds_read_b128 v[44:47], v10 offset:144
L_lwe_10:
    s_bitcmp1_b32 s42, 0
    s_cbranch_scc1 L_hV
    ds_read_b128 v[184:187], v10 offset:2816
    ds_read_b128 v[192:195], v10 offset:256
    ds_read_b128 v[188:191], v10 offset:2832
    ds_read_b128 v[196:199], v10 offset:272
    s_add_u32 m0, s68, 5120
    s_nop 0
    global_load_lds_dwordx4 v232, s[86:87]
    s_waitcnt lgkmcnt(8)
    v_pk_fma_f32 v[56:57], v[56:57], v[16:17], v[24:25]
    v_pk_fma_f32 v[58:59], v[58:59], v[18:19], v[26:27]
    v_pk_fma_f32 v[60:61], v[60:61], v[20:21], v[28:29]
    v_pk_fma_f32 v[62:63], v[62:63], v[22:23], v[30:31]
    v_cvt_pk_bf16_f32 v56, v56, v57
    v_cvt_pk_bf16_f32 v57, v58, v59
    v_cvt_pk_bf16_f32 v58, v60, v61
    v_cvt_pk_bf16_f32 v59, v62, v63
    ds_read_b128 v[16:19], v10 offset:2944
    ds_read_b128 v[24:27], v10 offset:384
    ds_read_b128 v[20:23], v10 offset:2960
    ds_read_b128 v[28:31], v10 offset:400
    s_add_u32 m0, s68, 6144
    s_nop 0
    global_load_lds_dwordx4 v233, s[86:87]
    s_waitcnt lgkmcnt(8)
    v_pk_fma_f32 v[64:65], v[64:65], v[32:33], v[40:41]
    v_pk_fma_f32 v[66:67], v[66:67], v[34:35], v[42:43]
    v_pk_fma_f32 v[68:69], v[68:69], v[36:37], v[44:45]
    v_pk_fma_f32 v[70:71], v[70:71], v[38:39], v[46:47]
    v_mfma_f32_16x16x32_bf16 v[136:139], v[144:147], v[56:59], 0
    v_cvt_pk_bf16_f32 v64, v64, v65
    v_cvt_pk_bf16_f32 v65, v66, v67
    v_cvt_pk_bf16_f32 v66, v68, v69
    v_cvt_pk_bf16_f32 v67, v70, v71
    ds_read_b128 v[32:35], v10 offset:3072
    ds_read_b128 v[40:43], v10 offset:512
    ds_read_b128 v[36:39], v10 offset:3088
    ds_read_b128 v[44:47], v10 offset:528
    s_add_u32 m0, s68, 7168
    s_nop 0
    global_load_lds_dwordx4 v234, s[86:87]
    s_waitcnt lgkmcnt(8)
    v_pk_fma_f32 v[72:73], v[72:73], v[184:185], v[192:193]
    v_pk_fma_f32 v[74:75], v[74:75], v[186:187], v[194:195]
    v_pk_fma_f32 v[76:77], v[76:77], v[188:189], v[196:197]
    v_pk_fma_f32 v[78:79], v[78:79], v[190:191], v[198:199]
    v_mfma_f32_16x16x32_bf16 v[136:139], v[148:151], v[64:67], v[136:139]
    v_cvt_pk_bf16_f32 v72, v72, v73
    v_cvt_pk_bf16_f32 v73, v74, v75
    v_cvt_pk_bf16_f32 v74, v76, v77
    v_cvt_pk_bf16_f32 v75, v78, v79
    ds_read_b128 v[184:187], v10 offset:3200
    ds_read_b128 v[192:195], v10 offset:640
    ds_read_b128 v[188:191], v10 offset:3216
    ds_read_b128 v[196:199], v10 offset:656
    s_add_u32 m0, s68, 8192
    s_nop 0
    global_load_lds_dwordx4 v235, s[86:87]
    s_waitcnt lgkmcnt(8)
    v_pk_fma_f32 v[80:81], v[80:81], v[16:17], v[24:25]
    v_pk_fma_f32 v[82:83], v[82:83], v[18:19], v[26:27]
    v_pk_fma_f32 v[84:85], v[84:85], v[20:21], v[28:29]
    v_pk_fma_f32 v[86:87], v[86:87], v[22:23], v[30:31]
    v_mfma_f32_16x16x32_bf16 v[136:139], v[152:155], v[72:75], v[136:139]
    v_cvt_pk_bf16_f32 v80, v80, v81
    v_cvt_pk_bf16_f32 v81, v82, v83
    v_cvt_pk_bf16_f32 v82, v84, v85
    v_cvt_pk_bf16_f32 v83, v86, v87
    ds_read_b128 v[16:19], v10 offset:3328
    ds_read_b128 v[24:27], v10 offset:768
    ds_read_b128 v[20:23], v10 offset:3344
    ds_read_b128 v[28:31], v10 offset:784
    s_add_u32 m0, s68, 9216
    s_nop 0
    global_load_lds_dwordx4 v236, s[86:87]
    s_waitcnt lgkmcnt(8)
    v_pk_fma_f32 v[88:89], v[88:89], v[32:33], v[40:41]
    v_pk_fma_f32 v[90:91], v[90:91], v[34:35], v[42:43]
    v_pk_fma_f32 v[92:93], v[92:93], v[36:37], v[44:45]
    v_pk_fma_f32 v[94:95], v[94:95], v[38:39], v[46:47]
    v_mfma_f32_16x16x32_bf16 v[136:139], v[156:159], v[80:83], v[136:139]
    v_cvt_pk_bf16_f32 v88, v88, v89
    v_cvt_pk_bf16_f32 v89, v90, v91
    v_cvt_pk_bf16_f32 v90, v92, v93
    v_cvt_pk_bf16_f32 v91, v94, v95
    ds_read_b128 v[32:35], v10 offset:3456
    ds_read_b128 v[40:43], v10 offset:896
    ds_read_b128 v[36:39], v10 offset:3472
    ds_read_b128 v[44:47], v10 offset:912
    s_waitcnt lgkmcnt(8)
    v_pk_fma_f32 v[96:97], v[96:97], v[184:185], v[192:193]
    v_pk_fma_f32 v[98:99], v[98:99], v[186:187], v[194:195]
    v_pk_fma_f32 v[100:101], v[100:101], v[188:189], v[196:197]
    v_pk_fma_f32 v[102:103], v[102:103], v[190:191], v[198:199]
    v_mfma_f32_16x16x32_bf16 v[136:139], v[160:163], v[88:91], v[136:139]
    v_cvt_pk_bf16_f32 v96, v96, v97
    v_cvt_pk_bf16_f32 v97, v98, v99
    v_cvt_pk_bf16_f32 v98, v100, v101
    v_cvt_pk_bf16_f32 v99, v102, v103
    ds_read_b128 v[184:187], v10 offset:3584
    ds_read_b128 v[192:195], v10 offset:1024
    ds_read_b128 v[188:191], v10 offset:3600
    ds_read_b128 v[196:199], v10 offset:1040
    s_waitcnt lgkmcnt(8)
    v_pk_fma_f32 v[104:105], v[104:105], v[16:17], v[24:25]
    v_pk_fma_f32 v[106:107], v[106:107], v[18:19], v[26:27]
    v_pk_fma_f32 v[108:109], v[108:109], v[20:21], v[28:29]
    v_pk_fma_f32 v[110:111], v[110:111], v[22:23], v[30:31]
    v_mfma_f32_16x16x32_bf16 v[136:139], v[164:167], v[96:99], v[136:139]
    v_cvt_pk_bf16_f32 v104, v104, v105
    v_cvt_pk_bf16_f32 v105, v106, v107
    v_cvt_pk_bf16_f32 v106, v108, v109
    v_cvt_pk_bf16_f32 v107, v110, v111
    ds_read_b128 v[16:19], v10 offset:3712
    ds_read_b128 v[24:27], v10 offset:1152
    ds_read_b128 v[20:23], v10 offset:3728
    ds_read_b128 v[28:31], v10 offset:1168
    s_waitcnt lgkmcnt(8)
    v_pk_fma_f32 v[112:113], v[112:113], v[32:33], v[40:41]
    v_pk_fma_f32 v[114:115], v[114:115], v[34:35], v[42:43]
    v_pk_fma_f32 v[116:117], v[116:117], v[36:37], v[44:45]
    v_pk_fma_f32 v[118:119], v[118:119], v[38:39], v[46:47]
    v_mfma_f32_16x16x32_bf16 v[136:139], v[168:171], v[104:107], v[136:139]
    v_cvt_pk_bf16_f32 v112, v112, v113
    v_cvt_pk_bf16_f32 v113, v114, v115
    v_cvt_pk_bf16_f32 v114, v116, v117
    v_cvt_pk_bf16_f32 v115, v118, v119
    s_waitcnt lgkmcnt(4)
    v_pk_fma_f32 v[120:121], v[120:121], v[184:185], v[192:193]
    v_pk_fma_f32 v[122:123], v[122:123], v[186:187], v[194:195]
    v_pk_fma_f32 v[124:125], v[124:125], v[188:189], v[196:197]
    v_pk_fma_f32 v[126:127], v[126:127], v[190:191], v[198:199]
    v_mfma_f32_16x16x32_bf16 v[136:139], v[172:175], v[112:115], v[136:139]
    v_cvt_pk_bf16_f32 v120, v120, v121
    v_cvt_pk_bf16_f32 v121, v122, v123
    v_cvt_pk_bf16_f32 v122, v124, v125
    v_cvt_pk_bf16_f32 v123, v126, v127
    s_waitcnt lgkmcnt(0)
    v_pk_fma_f32 v[128:129], v[128:129], v[16:17], v[24:25]
    v_pk_fma_f32 v[130:131], v[130:131], v[18:19], v[26:27]
    v_pk_fma_f32 v[132:133], v[132:133], v[20:21], v[28:29]
    v_pk_fma_f32 v[134:135], v[134:135], v[22:23], v[30:31]
    v_mfma_f32_16x16x32_bf16 v[136:139], v[176:179], v[120:123], v[136:139]
    v_cvt_pk_bf16_f32 v128, v128, v129
    v_cvt_pk_bf16_f32 v129, v130, v131
    v_cvt_pk_bf16_f32 v130, v132, v133
    v_cvt_pk_bf16_f32 v131, v134, v135
    s_nop 1
    v_mfma_f32_16x16x32_bf16 v[136:139], v[180:183], v[128:131], v[136:139]
    s_branch L_hdone
L_hV:
    ds_read_b128 v[184:187], v10 offset:2816
    ds_read_b128 v[192:195], v10 offset:256
    ds_read_b128 v[188:191], v10 offset:2832
    ds_read_b128 v[196:199], v10 offset:272
    s_add_u32 m0, s68, 5120
    s_nop 0
    global_load_lds_dwordx4 v232, s[86:87]
    s_waitcnt lgkmcnt(8)
    v_pk_fma_f32 v[56:57], v[56:57], v[16:17], v[24:25]
    v_pk_fma_f32 v[58:59], v[58:59], v[18:19], v[26:27]
    v_pk_fma_f32 v[60:61], v[60:61], v[20:21], v[28:29]
    v_pk_fma_f32 v[62:63], v[62:63], v[22:23], v[30:31]
    v_cvt_pk_bf16_f32 v56, v56, v57
    v_cvt_pk_bf16_f32 v57, v58, v59
    v_cvt_pk_bf16_f32 v58, v60, v61
    v_cvt_pk_bf16_f32 v59, v62, v63
    ds_read_b128 v[16:19], v10 offset:2944
    ds_read_b128 v[24:27], v10 offset:384
    ds_read_b128 v[20:23], v10 offset:2960
    ds_read_b128 v[28:31], v10 offset:400
    s_add_u32 m0, s68, 6144
    s_nop 0
    global_load_lds_dwordx4 v233, s[86:87]
    s_waitcnt lgkmcnt(8)
    v_pk_fma_f32 v[64:65], v[64:65], v[32:33], v[40:41]
    v_pk_fma_f32 v[66:67], v[66:67], v[34:35], v[42:43]
    v_pk_fma_f32 v[68:69], v[68:69], v[36:37], v[44:45]
    v_pk_fma_f32 v[70:71], v[70:71], v[38:39], v[46:47]
    v_mfma_f32_16x16x32_bf16 v[136:139], v[56:59], v[144:147], 0
    v_cvt_pk_bf16_f32 v64, v64, v65
    v_cvt_pk_bf16_f32 v65, v66, v67
    v_cvt_pk_bf16_f32 v66, v68, v69
    v_cvt_pk_bf16_f32 v67, v70, v71
    ds_read_b128 v[32:35], v10 offset:3072
    ds_read_b128 v[40:43], v10 offset:512
    ds_read_b128 v[36:39], v10 offset:3088
    ds_read_b128 v[44:47], v10 offset:528
    s_add_u32 m0, s68, 7168
    s_nop 0
    global_load_lds_dwordx4 v234, s[86:87]
    s_waitcnt lgkmcnt(8)
    v_pk_fma_f32 v[72:73], v[72:73], v[184:185], v[192:193]
    v_pk_fma_f32 v[74:75], v[74:75], v[186:187], v[194:195]
    v_pk_fma_f32 v[76:77], v[76:77], v[188:189], v[196:197]
    v_pk_fma_f32 v[78:79], v[78:79], v[190:191], v[198:199]
    v_mfma_f32_16x16x32_bf16 v[136:139], v[64:67], v[148:151], v[136:139]
    v_cvt_pk_bf16_f32 v72, v72, v73
    v_cvt_pk_bf16_f32 v73, v74, v75
    v_cvt_pk_bf16_f32 v74, v76, v77
    v_cvt_pk_bf16_f32 v75, v78, v79
    ds_read_b128 v[184:187], v10 offset:3200
    ds_read_b128 v[192:195], v10 offset:640
    ds_read_b128 v[188:191], v10 offset:3216
    ds_read_b128 v[196:199], v10 offset:656
    s_add_u32 m0, s68, 8192
    s_nop 0
    global_load_lds_dwordx4 v235, s[86:87]
    s_waitcnt lgkmcnt(8)
    v_pk_fma_f32 v[80:81], v[80:81], v[16:17], v[24:25]
    v_pk_fma_f32 v[82:83], v[82:83], v[18:19], v[26:27]
    v_pk_fma_f32 v[84:85], v[84:85], v[20:21], v[28:29]
    v_pk_fma_f32 v[86:87], v[86:87], v[22:23], v[30:31]
    v_mfma_f32_16x16x32_bf16 v[136:139], v[72:75], v[152:155], v[136:139]
    v_cvt_pk_bf16_f32 v80, v80, v81
    v_cvt_pk_bf16_f32 v81, v82, v83
    v_cvt_pk_bf16_f32 v82, v84, v85
    v_cvt_pk_bf16_f32 v83, v86, v87
    ds_read_b128 v[16:19], v10 offset:3328
    ds_read_b128 v[24:27], v10 offset:768
    ds_read_b128 v[20:23], v10 offset:3344
    ds_read_b128 v[28:31], v10 offset:784
    s_add_u32 m0, s68, 9216
    s_nop 0
    global_load_lds_dwordx4 v236, s[86:87]
    s_waitcnt lgkmcnt(8)
    v_pk_fma_f32 v[88:89], v[88:89], v[32:33], v[40:41]
    v_pk_fma_f32 v[90:91], v[90:91], v[34:35], v[42:43]
    v_pk_fma_f32 v[92:93], v[92:93], v[36:37], v[44:45]
    v_pk_fma_f32 v[94:95], v[94:95], v[38:39], v[46:47]
    v_mfma_f32_16x16x32_bf16 v[136:139], v[80:83], v[156:159], v[136:139]
    v_cvt_pk_bf16_f32 v88, v88, v89
    v_cvt_pk_bf16_f32 v89, v90, v91
    v_cvt_pk_bf16_f32 v90, v92, v93
    v_cvt_pk_bf16_f32 v91, v94, v95
    ds_read_b128 v[32:35], v10 offset:3456
    ds_read_b128 v[40:43], v10 offset:896
    ds_read_b128 v[36:39], v10 offset:3472
    ds_read_b128 v[44:47], v10 offset:912
    s_waitcnt lgkmcnt(8)
    v_pk_fma_f32 v[96:97], v[96:97], v[184:185], v[192:193]
    v_pk_fma_f32 v[98:99], v[98:99], v[186:187], v[194:195]
    v_pk_fma_f32 v[100:101], v[100:101], v[188:189], v[196:197]
    v_pk_fma_f32 v[102:103], v[102:103], v[190:191], v[198:199]
    v_mfma_f32_16x16x32_bf16 v[136:139], v[88:91], v[160:163], v[136:139]
    v_cvt_pk_bf16_f32 v96, v96, v97
    v_cvt_pk_bf16_f32 v97, v98, v99
    v_cvt_pk_bf16_f32 v98, v100, v101
    v_cvt_pk_bf16_f32 v99, v102, v103
    ds_read_b128 v[184:187], v10 offset:3584
    ds_read_b128 v[192:195], v10 offset:1024
    ds_read_b128 v[188:191], v10 offset:3600
    ds_read_b128 v[196:199], v10 offset:1040
    s_waitcnt lgkmcnt(8)
    v_pk_fma_f32 v[104:105], v[104:105], v[16:17], v[24:25]
    v_pk_fma_f32 v[106:107], v[106:107], v[18:19], v[26:27]
    v_pk_fma_f32 v[108:109], v[108:109], v[20:21], v[28:29]
    v_pk_fma_f32 v[110:111], v[110:111], v[22:23], v[30:31]
    v_mfma_f32_16x16x32_bf16 v[136:139], v[96:99], v[164:167], v[136:139]
    v_cvt_pk_bf16_f32 v104, v104, v105
    v_cvt_pk_bf16_f32 v105, v106, v107
    v_cvt_pk_bf16_f32 v106, v108, v109
    v_cvt_pk_bf16_f32 v107, v110, v111
    ds_read_b128 v[16:19], v10 offset:3712
    ds_read_b128 v[24:27], v10 offset:1152
    ds_read_b128 v[20:23], v10 offset:3728
    ds_read_b128 v[28:31], v10 offset:1168
    s_waitcnt lgkmcnt(8)
    v_pk_fma_f32 v[112:113], v[112:113], v[32:33], v[40:41]
    v_pk_fma_f32 v[114:115], v[114:115], v[34:35], v[42:43]
    v_pk_fma_f32 v[116:117], v[116:117], v[36:37], v[44:45]
    v_pk_fma_f32 v[118:119], v[118:119], v[38:39], v[46:47]
    v_mfma_f32_16x16x32_bf16 v[136:139], v[104:107], v[168:171], v[136:139]
    v_cvt_pk_bf16_f32 v112, v112, v113
    v_cvt_pk_bf16_f32 v113, v114, v115
    v_cvt_pk_bf16_f32 v114, v116, v117
    v_cvt_pk_bf16_f32 v115, v118, v119
    s_waitcnt lgkmcnt(4)
    v_pk_fma_f32 v[120:121], v[120:121], v[184:185], v[192:193]
    v_pk_fma_f32 v[122:123], v[122:123], v[186:187], v[194:195]
    v_pk_fma_f32 v[124:125], v[124:125], v[188:189], v[196:197]
    v_pk_fma_f32 v[126:127], v[126:127], v[190:191], v[198:199]
    v_mfma_f32_16x16x32_bf16 v[136:139], v[112:115], v[172:175], v[136:139]
    v_cvt_pk_bf16_f32 v120, v120, v121
    v_cvt_pk_bf16_f32 v121, v122, v123
    v_cvt_pk_bf16_f32 v122, v124, v125
    v_cvt_pk_bf16_f32 v123, v126, v127
    s_waitcnt lgkmcnt(0)
    v_pk_fma_f32 v[128:129], v[128:129], v[16:17], v[24:25]
    v_pk_fma_f32 v[130:131], v[130:131], v[18:19], v[26:27]
    v_pk_fma_f32 v[132:133], v[132:133], v[20:21], v[28:29]
    v_pk_fma_f32 v[134:135], v[134:135], v[22:23], v[30:31]
    v_mfma_f32_16x16x32_bf16 v[136:139], v[120:123], v[176:179], v[136:139]
    v_cvt_pk_bf16_f32 v128, v128, v129
    v_cvt_pk_bf16_f32 v129, v130, v131
    v_cvt_pk_bf16_f32 v130, v132, v133
    v_cvt_pk_bf16_f32 v131, v134, v135
    s_nop 1
    v_mfma_f32_16x16x32_bf16 v[136:139], v[128:131], v[180:183], v[136:139]
L_hdone:
    s_mov_b32 s54, 0x3ea52b5c
    s_mov_b32 s56, 0x0f0f0f0f
    s_mov_b32 s57, 0x0f0f0f0f
    s_nop 4
    ds_write_b128 v9, v[136:139]
    s_cmp_eq_u32 s40, 0
    s_cbranch_scc1 L_kvA
    s_waitcnt lgkmcnt(0)
    s_barrier
    s_cmp_lt_u32 s42, 4
    s_cbranch_scc1 L_kvB1
    ds_read_b128 v[136:139], v208
    ds_read_b128 v[140:143], v208 offset:1024
    s_waitcnt lgkmcnt(0)
    v_pk_add_f32 v[136:137], v[136:137], v[140:141]
    v_pk_add_f32 v[138:139], v[138:139], v[142:143]
    v_cvt_pk_bf16_f32 v14, v136, v137
    v_cvt_pk_bf16_f32 v15, v138, v139
    v_cndmask_b32 v14, v14, v12, s[80:81]
    v_cndmask_b32 v15, v15, v13, s[80:81]
    s_mov_b64 exec, s[78:79]
    global_store_dwordx2 v11, v[14:15], s[36:37] sc1
L_kvB2:
    s_mov_b64 exec, 0xffff
    s_cmp_lg_u32 s38, 4
    s_waitcnt vmcnt(0)
    s_barrier
    s_cbranch_scc1 L_nokf
    global_store_dwordx2 v237, v[238:239], s[36:37] sc1
L_nokf:
    s_mov_b64 exec, -1
    s_setprio 2
    s_branch L_kvR
L_kvB1:
    s_waitcnt vmcnt(0)
    s_branch L_kvB2
L_kvA:
    s_setprio 2
    s_waitcnt lgkmcnt(0)
    s_barrier
    s_waitcnt vmcnt(0)
    s_barrier
L_kvR:
    ds_read_b64_tr_b16 v[156:157], v8 offset:0
    ds_read_b64_tr_b16 v[158:159], v8 offset:2560
    ds_read_b64_tr_b16 v[160:161], v8 offset:8
    ds_read_b64_tr_b16 v[162:163], v8 offset:2568
    ds_read_b64_tr_b16 v[164:165], v8 offset:16
    ds_read_b64_tr_b16 v[166:167], v8 offset:2576
    ds_read_b64_tr_b16 v[168:169], v8 offset:24
    ds_read_b64_tr_b16 v[170:171], v8 offset:2584
    ds_read_b64_tr_b16 v[172:173], v8 offset:32
    ds_read_b64_tr_b16 v[174:175], v8 offset:2592
    ds_read_b64_tr_b16 v[176:177], v8 offset:5120
    ds_read_b64_tr_b16 v[178:179], v8 offset:7680
    ds_read_b64_tr_b16 v[180:181], v8 offset:5128
    ds_read_b64_tr_b16 v[182:183], v8 offset:7688
    s_waitcnt lgkmcnt(10)
    v_mfma_f32_16x16x32_bf16 v[136:139], v[156:159], v[56:59], 0
    ds_read_b64_tr_b16 v[184:185], v8 offset:5136
    ds_read_b64_tr_b16 v[186:187], v8 offset:7696
    v_mfma_f32_16x16x32_bf16 v[140:143], v[160:163], v[56:59], 0
    ds_read_b64_tr_b16 v[188:189], v8 offset:5144
    ds_read_b64_tr_b16 v[190:191], v8 offset:7704
    s_waitcnt lgkmcnt(10)
    v_mfma_f32_16x16x32_bf16 v[144:147], v[164:167], v[56:59], 0
    ds_read_b64_tr_b16 v[192:193], v8 offset:5152
    ds_read_b64_tr_b16 v[194:195], v8 offset:7712
    v_mfma_f32_16x16x32_bf16 v[148:151], v[168:171], v[56:59], 0
    ds_read_b64_tr_b16 v[16:17], v8 offset:10240
    ds_read_b64_tr_b16 v[18:19], v8 offset:12800
    s_waitcnt lgkmcnt(10)
    v_mfma_f32_16x16x32_bf16 v[152:155], v[172:175], v[56:59], 0
    ds_read_b64_tr_b16 v[20:21], v8 offset:10248
    ds_read_b64_tr_b16 v[22:23], v8 offset:12808
    v_mfma_f32_16x16x32_bf16 v[136:139], v[176:179], v[64:67], v[136:139]
    ds_read_b64_tr_b16 v[24:25], v8 offset:10256
    ds_read_b64_tr_b16 v[26:27], v8 offset:12816
    s_waitcnt lgkmcnt(10)
    v_mfma_f32_16x16x32_bf16 v[140:143], v[180:183], v[64:67], v[140:143]
    ds_read_b64_tr_b16 v[28:29], v8 offset:10264
    ds_read_b64_tr_b16 v[30:31], v8 offset:12824
    v_mfma_f32_16x16x32_bf16 v[144:147], v[184:187], v[64:67], v[144:147]
    ds_read_b64_tr_b16 v[32:33], v8 offset:10272
    ds_read_b64_tr_b16 v[34:35], v8 offset:12832
    s_waitcnt lgkmcnt(10)
    v_mfma_f32_16x16x32_bf16 v[148:151], v[188:191], v[64:67], v[148:151]
    ds_read_b64_tr_b16 v[156:157], v8 offset:15360
    ds_read_b64_tr_b16 v[158:159], v8 offset:17920
    v_mfma_f32_16x16x32_bf16 v[152:155], v[192:195], v[64:67], v[152:155]
    ds_read_b64_tr_b16 v[160:161], v8 offset:15368
    ds_read_b64_tr_b16 v[162:163], v8 offset:17928
    s_waitcnt lgkmcnt(10)
    v_mfma_f32_16x16x32_bf16 v[136:139], v[16:19], v[72:75], v[136:139]
    ds_read_b64_tr_b16 v[164:165], v8 offset:15376
    ds_read_b64_tr_b16 v[166:167], v8 offset:17936
    v_mfma_f32_16x16x32_bf16 v[140:143], v[20:23], v[72:75], v[140:143]
    ds_read_b64_tr_b16 v[168:169], v8 offset:15384
    ds_read_b64_tr_b16 v[170:171], v8 offset:17944
    s_waitcnt lgkmcnt(10)
    v_mfma_f32_16x16x32_bf16 v[144:147], v[24:27], v[72:75], v[144:147]
    ds_read_b64_tr_b16 v[172:173], v8 offset:15392
    ds_read_b64_tr_b16 v[174:175], v8 offset:17952
    v_mfma_f32_16x16x32_bf16 v[148:151], v[28:31], v[72:75], v[148:151]
    ds_read_b64_tr_b16 v[176:177], v8 offset:20480
    ds_read_b64_tr_b16 v[178:179], v8 offset:23040
    s_waitcnt lgkmcnt(10)
    v_mfma_f32_16x16x32_bf16 v[152:155], v[32:35], v[72:75], v[152:155]
    ds_read_b64_tr_b16 v[180:181], v8 offset:20488
    ds_read_b64_tr_b16 v[182:183], v8 offset:23048
    v_mfma_f32_16x16x32_bf16 v[136:139], v[156:159], v[80:83], v[136:139]
    ds_read_b64_tr_b16 v[184:185], v8 offset:20496
    ds_read_b64_tr_b16 v[186:187], v8 offset:23056
    s_waitcnt lgkmcnt(10)
    v_mfma_f32_16x16x32_bf16 v[140:143], v[160:163], v[80:83], v[140:143]
    ds_read_b64_tr_b16 v[188:189], v8 offset:20504
    ds_read_b64_tr_b16 v[190:191], v8 offset:23064
    v_mfma_f32_16x16x32_bf16 v[144:147], v[164:167], v[80:83], v[144:147]
    ds_read_b64_tr_b16 v[192:193], v8 offset:20512
    ds_read_b64_tr_b16 v[194:195], v8 offset:23072
    s_waitcnt lgkmcnt(10)
    v_mfma_f32_16x16x32_bf16 v[148:151], v[168:171], v[80:83], v[148:151]
    ds_read_b64_tr_b16 v[16:17], v8 offset:25600
    ds_read_b64_tr_b16 v[18:19], v8 offset:28160
    v_mfma_f32_16x16x32_bf16 v[152:155], v[172:175], v[80:83], v[152:155]
    ds_read_b64_tr_b16 v[20:21], v8 offset:25608
    ds_read_b64_tr_b16 v[22:23], v8 offset:28168
    s_waitcnt lgkmcnt(10)
    v_mfma_f32_16x16x32_bf16 v[136:139], v[176:179], v[88:91], v[136:139]
    ds_read_b64_tr_b16 v[24:25], v8 offset:25616
    ds_read_b64_tr_b16 v[26:27], v8 offset:28176
    v_mfma_f32_16x16x32_bf16 v[140:143], v[180:183], v[88:91], v[140:143]
    ds_read_b64_tr_b16 v[28:29], v8 offset:25624
    ds_read_b64_tr_b16 v[30:31], v8 offset:28184
    s_waitcnt lgkmcnt(10)
    v_mfma_f32_16x16x32_bf16 v[144:147], v[184:187], v[88:91], v[144:147]
    ds_read_b64_tr_b16 v[32:33], v8 offset:25632
    ds_read_b64_tr_b16 v[34:35], v8 offset:28192
    v_mfma_f32_16x16x32_bf16 v[148:151], v[188:191], v[88:91], v[148:151]
    ds_read_b64_tr_b16 v[156:157], v8 offset:30720
    ds_read_b64_tr_b16 v[158:159], v8 offset:33280
    s_waitcnt lgkmcnt(10)
    v_mfma_f32_16x16x32_bf16 v[152:155], v[192:195], v[88:91], v[152:155]
    ds_read_b64_tr_b16 v[160:161], v8 offset:30728
    ds_read_b64_tr_b16 v[162:163], v8 offset:33288
    v_mfma_f32_16x16x32_bf16 v[136:139], v[16:19], v[96:99], v[136:139]
    ds_read_b64_tr_b16 v[164:165], v8 offset:30736
    ds_read_b64_tr_b16 v[166:167], v8 offset:33296
    s_waitcnt lgkmcnt(10)
    v_mfma_f32_16x16x32_bf16 v[140:143], v[20:23], v[96:99], v[140:143]
    ds_read_b64_tr_b16 v[168:169], v8 offset:30744
    ds_read_b64_tr_b16 v[170:171], v8 offset:33304
    v_mfma_f32_16x16x32_bf16 v[144:147], v[24:27], v[96:99], v[144:147]
    ds_read_b64_tr_b16 v[172:173], v8 offset:30752
    ds_read_b64_tr_b16 v[174:175], v8 offset:33312
    s_waitcnt lgkmcnt(10)
    v_mfma_f32_16x16x32_bf16 v[148:151], v[28:31], v[96:99], v[148:151]
    ds_read_b64_tr_b16 v[176:177], v8 offset:35840
    ds_read_b64_tr_b16 v[178:179], v8 offset:38400
    v_mfma_f32_16x16x32_bf16 v[152:155], v[32:35], v[96:99], v[152:155]
    ds_read_b64_tr_b16 v[180:181], v8 offset:35848
    ds_read_b64_tr_b16 v[182:183], v8 offset:38408
    s_waitcnt lgkmcnt(10)
    v_mfma_f32_16x16x32_bf16 v[136:139], v[156:159], v[104:107], v[136:139]
    ds_read_b64_tr_b16 v[184:185], v8 offset:35856
    ds_read_b64_tr_b16 v[186:187], v8 offset:38416
    v_mfma_f32_16x16x32_bf16 v[140:143], v[160:163], v[104:107], v[140:143]
    ds_read_b64_tr_b16 v[188:189], v8 offset:35864
    ds_read_b64_tr_b16 v[190:191], v8 offset:38424
    s_waitcnt lgkmcnt(10)
    v_mfma_f32_16x16x32_bf16 v[144:147], v[164:167], v[104:107], v[144:147]
    ds_read_b64_tr_b16 v[192:193], v8 offset:35872
    ds_read_b64_tr_b16 v[194:195], v8 offset:38432
    v_mfma_f32_16x16x32_bf16 v[148:151], v[168:171], v[104:107], v[148:151]
    ds_read_b64_tr_b16 v[16:17], v8 offset:40960
    ds_read_b64_tr_b16 v[18:19], v8 offset:43520
    s_waitcnt lgkmcnt(10)
    v_mfma_f32_16x16x32_bf16 v[152:155], v[172:175], v[104:107], v[152:155]
    ds_read_b64_tr_b16 v[20:21], v8 offset:40968
    ds_read_b64_tr_b16 v[22:23], v8 offset:43528
    v_mfma_f32_16x16x32_bf16 v[136:139], v[176:179], v[112:115], v[136:139]
    ds_read_b64_tr_b16 v[24:25], v8 offset:40976
    ds_read_b64_tr_b16 v[26:27], v8 offset:43536
    s_waitcnt lgkmcnt(10)
    v_mfma_f32_16x16x32_bf16 v[140:143], v[180:183], v[112:115], v[140:143]
    ds_read_b64_tr_b16 v[28:29], v8 offset:40984
    ds_read_b64_tr_b16 v[30:31], v8 offset:43544
    v_mfma_f32_16x16x32_bf16 v[144:147], v[184:187], v[112:115], v[144:147]
    ds_read_b64_tr_b16 v[32:33], v8 offset:40992
    ds_read_b64_tr_b16 v[34:35], v8 offset:43552
    s_waitcnt lgkmcnt(10)
    v_mfma_f32_16x16x32_bf16 v[148:151], v[188:191], v[112:115], v[148:151]
    ds_read_b64_tr_b16 v[156:157], v8 offset:46080
    ds_read_b64_tr_b16 v[158:159], v8 offset:48640
    v_mfma_f32_16x16x32_bf16 v[152:155], v[192:195], v[112:115], v[152:155]
    ds_read_b64_tr_b16 v[160:161], v8 offset:46088
    ds_read_b64_tr_b16 v[162:163], v8 offset:48648
    s_waitcnt lgkmcnt(10)
    v_mfma_f32_16x16x32_bf16 v[136:139], v[16:19], v[120:123], v[136:139]
    ds_read_b64_tr_b16 v[164:165], v8 offset:46096
    ds_read_b64_tr_b16 v[166:167], v8 offset:48656
    s_setprio 3
    v_mfma_f32_16x16x32_bf16 v[140:143], v[20:23], v[120:123], v[140:143]
    ds_read_b64_tr_b16 v[168:169], v8 offset:46104
    ds_read_b64_tr_b16 v[170:171], v8 offset:48664
    s_waitcnt lgkmcnt(10)
    v_mfma_f32_16x16x32_bf16 v[144:147], v[24:27], v[120:123], v[144:147]
    ds_read_b64_tr_b16 v[172:173], v8 offset:46112
    ds_read_b64_tr_b16 v[174:175], v8 offset:48672
    v_mfma_f32_16x16x32_bf16 v[148:151], v[28:31], v[120:123], v[148:151]
    s_waitcnt lgkmcnt(8)
    v_mfma_f32_16x16x32_bf16 v[152:155], v[32:35], v[120:123], v[152:155]
    v_mfma_f32_16x16x32_bf16 v[136:139], v[156:159], v[128:131], v[136:139]
    s_waitcnt lgkmcnt(4)
    v_mfma_f32_16x16x32_bf16 v[140:143], v[160:163], v[128:131], v[140:143]
    v_mfma_f32_16x16x32_bf16 v[144:147], v[164:167], v[128:131], v[144:147]
    s_waitcnt lgkmcnt(0)
    v_mfma_f32_16x16x32_bf16 v[148:151], v[168:171], v[128:131], v[148:151]
    v_mfma_f32_16x16x32_bf16 v[152:155], v[172:175], v[128:131], v[152:155]
    s_add_u32 s45, s45, 4
    s_cmp_lg_u32 s71, 0
    s_cbranch_scc1 L_ex1
    s_nop 1
    ds_write_b128 v208, v[144:147] offset:0
    s_nop 0
    ds_write_b128 v208, v[148:151] offset:1024
    s_mov_b64 exec, 1
    ds_add_u32 v214, v215
    s_mov_b64 exec, -1
    v_mul_f32 v136, s54, v136
    v_mul_f32 v137, s54, v137
    v_mul_f32 v138, s54, v138
    v_mul_f32 v139, s54, v139
    v_mul_f32 v140, s54, v140
    v_mul_f32 v141, s54, v141
    v_mul_f32 v142, s54, v142
    v_mul_f32 v143, s54, v143
    v_mul_f32 v152, s54, v152
    v_mul_f32 v153, s54, v153
    v_mul_f32 v154, s54, v154
    v_mul_f32 v155, s54, v155
    s_mov_b32 s47, 1048576
L_lw_11:
    ds_read_b32 v134, v214
    s_waitcnt lgkmcnt(0)
    v_readfirstlane_b32 s63, v134
    s_nop 0
    s_cmp_ge_u32 s63, s45
    s_cbranch_scc1 L_lwr_12
    s_sub_u32 s47, s47, 1
    s_cbranch_scc0 L_lw_11
L_lwr_12:
    ds_read_b128 v[116:119], v209 offset:0
    ds_read_b128 v[120:123], v209 offset:1024
    ds_read_b128 v[124:127], v209 offset:2048
L_lwe_13:
    s_cmp_lg_u32 s40, 0
    s_cbranch_scc1 L_kq0
    s_mov_b64 exec, s[56:57]
    global_load_dword v135, v213, s[36:37] sc1
    s_mov_b64 exec, -1
L_kq0:
    s_waitcnt lgkmcnt(2)
    v_fmac_f32 v136, s54, v116
    v_fmac_f32 v137, s54, v117
    v_fmac_f32 v138, s54, v118
    v_fmac_f32 v139, s54, v119
    v_cvt_pk_bf16_f32 v128, v136, v137
    v_cvt_pk_bf16_f32 v129, v138, v139
    s_waitcnt lgkmcnt(1)
    v_fmac_f32 v140, s54, v120
    v_fmac_f32 v141, s54, v121
    v_fmac_f32 v142, s54, v122
    v_fmac_f32 v143, s54, v123
    v_cvt_pk_bf16_f32 v130, v140, v141
    v_cvt_pk_bf16_f32 v131, v142, v143
    s_waitcnt lgkmcnt(0)
    v_fmac_f32 v152, s54, v124
    v_fmac_f32 v153, s54, v125
    v_fmac_f32 v154, s54, v126
    v_fmac_f32 v155, s54, v127
    v_cvt_pk_bf16_f32 v132, v152, v153
    v_cvt_pk_bf16_f32 v133, v154, v155
    s_mov_b32 s46, 0
    s_cmp_lg_u32 s40, 0
    s_cbranch_scc1 L_kw0
    s_mov_b64 exec, s[56:57]
    s_waitcnt vmcnt(0)
    v_cmp_ne_u32 vcc, s43, v135
    s_nop 0
    s_cbranch_vccz L_kx0
    s_mov_b64 exec, -1
    s_branch L_kw0
L_kx0:
    s_mov_b64 exec, -1
    s_mov_b32 s46, 1
    s_mul_i32 s68, s39, 43008
    s_add_u32 s92, s68, 5376
    buffer_load_dwordx4 v[40:43], v240, s[48:51], s68 offen offset:0 sc1
    buffer_load_dwordx2 v[48:49], v241, s[48:51], s68 offen offset:2048 sc1
    buffer_load_dwordx4 v[52:55], v242, s[48:51], s68 offen offset:0 sc1
    buffer_load_dwordx4 v[56:59], v242, s[48:51], s68 offen offset:672 sc1
    buffer_load_dwordx4 v[44:47], v240, s[48:51], s68 offen offset:1024 sc1
    buffer_load_dwordx4 v[60:63], v242, s[48:51], s68 offen offset:1344 sc1
    buffer_load_dwordx4 v[64:67], v242, s[48:51], s68 offen offset:2016 sc1
    buffer_load_dwordx4 v[68:71], v240, s[48:51], s92 offen offset:0 sc1
    buffer_load_dwordx4 v[80:83], v242, s[48:51], s92 offen offset:0 sc1
    buffer_load_dwordx4 v[84:87], v242, s[48:51], s92 offen offset:672 sc1
    buffer_load_dwordx4 v[72:75], v240, s[48:51], s92 offen offset:1024 sc1
    buffer_load_dwordx2 v[76:77], v241, s[48:51], s92 offen offset:2048 sc1
L_kw0:
    ds_write_b128 v210, v[128:131] offset:0
    ds_write_b64 v211, v[132:133] offset:1024
    s_branch L_exd
L_ex1:
    ds_write_b128 v208, v[136:139] offset:0
    ds_write_b128 v208, v[140:143] offset:1024
    s_nop 2
    ds_write_b128 v208, v[152:155] offset:2048
    s_mov_b64 exec, 1
    ds_add_u32 v214, v215
    s_mov_b64 exec, -1
    v_mul_f32 v144, s54, v144
    v_mul_f32 v145, s54, v145
    v_mul_f32 v146, s54, v146
    v_mul_f32 v147, s54, v147
    v_mul_f32 v148, s54, v148
    v_mul_f32 v149, s54, v149
    v_mul_f32 v150, s54, v150
    v_mul_f32 v151, s54, v151
    s_mov_b32 s47, 1048576
L_lw_14:
    ds_read_b32 v134, v214
    s_waitcnt lgkmcnt(0)
    v_readfirstlane_b32 s63, v134
    s_nop 0
    s_cmp_ge_u32 s63, s45
    s_cbranch_scc1 L_lwr_15
    s_sub_u32 s47, s47, 1
    s_cbranch_scc0 L_lw_14
L_lwr_15:
    ds_read_b128 v[116:119], v209 offset:0
    ds_read_b128 v[120:123], v209 offset:1024
L_lwe_16:
    s_cmp_lg_u32 s40, 0
    s_cbranch_scc1 L_kq1
    s_mov_b64 exec, s[56:57]
    global_load_dword v135, v213, s[36:37] sc1
    s_mov_b64 exec, -1
L_kq1:
    s_waitcnt lgkmcnt(1)
    v_fmac_f32 v144, s54, v116
    v_fmac_f32 v145, s54, v117
    v_fmac_f32 v146, s54, v118
    v_fmac_f32 v147, s54, v119
    v_cvt_pk_bf16_f32 v128, v144, v145
    v_cvt_pk_bf16_f32 v129, v146, v147
    s_waitcnt lgkmcnt(0)
    v_fmac_f32 v148, s54, v120
    v_fmac_f32 v149, s54, v121
    v_fmac_f32 v150, s54, v122
    v_fmac_f32 v151, s54, v123
    v_cvt_pk_bf16_f32 v130, v148, v149
    v_cvt_pk_bf16_f32 v131, v150, v151
    s_mov_b32 s46, 0
    s_cmp_lg_u32 s40, 0
    s_cbranch_scc1 L_kw1
    s_mov_b64 exec, s[56:57]
    s_waitcnt vmcnt(0)
    v_cmp_ne_u32 vcc, s43, v135
    s_nop 0
    s_cbranch_vccz L_kx1
    s_mov_b64 exec, -1
    s_branch L_kw1
L_kx1:
    s_mov_b64 exec, -1
    s_mov_b32 s46, 1
    s_mul_i32 s68, s39, 43008
    s_add_u32 s92, s68, 5376
    buffer_load_dwordx4 v[40:43], v240, s[48:51], s68 offen offset:0 sc1
    buffer_load_dwordx2 v[48:49], v241, s[48:51], s68 offen offset:2048 sc1
    buffer_load_dwordx4 v[52:55], v242, s[48:51], s68 offen offset:0 sc1
    buffer_load_dwordx4 v[56:59], v242, s[48:51], s68 offen offset:672 sc1
    buffer_load_dwordx4 v[44:47], v240, s[48:51], s68 offen offset:1024 sc1
    buffer_load_dwordx4 v[60:63], v242, s[48:51], s68 offen offset:1344 sc1
    buffer_load_dwordx4 v[64:67], v242, s[48:51], s68 offen offset:2016 sc1
    buffer_load_dwordx4 v[68:71], v240, s[48:51], s92 offen offset:0 sc1
    buffer_load_dwordx4 v[80:83], v242, s[48:51], s92 offen offset:0 sc1
    buffer_load_dwordx4 v[84:87], v242, s[48:51], s92 offen offset:672 sc1
    buffer_load_dwordx4 v[72:75], v240, s[48:51], s92 offen offset:1024 sc1
    buffer_load_dwordx2 v[76:77], v241, s[48:51], s92 offen offset:2048 sc1
L_kw1:
    ds_write_b128 v210, v[128:131] offset:512
L_exd:
    s_add_u32 s45, s45, 4
    s_mov_b64 exec, 1
    ds_add_u32 v214, v215
    s_mov_b64 exec, -1
    s_cmp_lg_u32 s40, 0
    s_cbranch_scc1 L_goB
    s_cmp_lg_u32 s46, 0
    s_cbranch_scc1 L_kvin
    s_mov_b64 exec, s[56:57]
    s_waitcnt vmcnt(0)
    v_cmp_ne_u32 vcc, s43, v135
    s_nop 0
    s_cbranch_vccz L_kvok
    s_mov_b64 exec, vcc
    s_mov_b32 s47, 131072
L_pm_17:
    global_load_dword v135, v213, s[36:37] sc1
    s_waitcnt vmcnt(0)
    v_cmp_ne_u32 vcc, s43, v135
    s_nop 0
    s_cbranch_vccz L_pme_18
    s_mov_b64 exec, vcc
    s_sub_u32 s47, s47, 1
    s_cbranch_scc0 L_pm_17
L_pme_18:
    s_mov_b64 exec, -1
L_kvok:
    s_mov_b64 exec, -1
    s_mul_i32 s68, s39, 43008
    s_add_u32 s92, s68, 5376
    buffer_load_dwordx4 v[40:43], v240, s[48:51], s68 offen offset:0 sc1
    buffer_load_dwordx2 v[48:49], v241, s[48:51], s68 offen offset:2048 sc1
    buffer_load_dwordx4 v[52:55], v242, s[48:51], s68 offen offset:0 sc1
    buffer_load_dwordx4 v[56:59], v242, s[48:51], s68 offen offset:672 sc1
    buffer_load_dwordx4 v[44:47], v240, s[48:51], s68 offen offset:1024 sc1
    buffer_load_dwordx4 v[60:63], v242, s[48:51], s68 offen offset:1344 sc1
    buffer_load_dwordx4 v[64:67], v242, s[48:51], s68 offen offset:2016 sc1
    buffer_load_dwordx4 v[68:71], v240, s[48:51], s92 offen offset:0 sc1
    buffer_load_dwordx4 v[80:83], v242, s[48:51], s92 offen offset:0 sc1
    buffer_load_dwordx4 v[84:87], v242, s[48:51], s92 offen offset:672 sc1
    buffer_load_dwordx4 v[72:75], v240, s[48:51], s92 offen offset:1024 sc1
    buffer_load_dwordx2 v[76:77], v241, s[48:51], s92 offen offset:2048 sc1
L_kvin:
    v_mov_b32 v36, 160312
    v_mov_b32 v37, 1
    s_mov_b64 exec, 1
    ds_add_u32 v36, v37
    s_mov_b64 exec, -1
    s_mov_b32 s47, 1048576
L_lw_19:
    ds_read_b32 v134, v214
    s_waitcnt lgkmcnt(0)
    v_readfirstlane_b32 s63, v134
    s_nop 0
    s_cmp_ge_u32 s63, s45
    s_cbranch_scc1 L_lwr_20
    s_sub_u32 s47, s47, 1
    s_cbranch_scc0 L_lw_19
L_lwr_20:
    ds_read_b64 v[32:33], v204 offset:1024
    ds_read_b64 v[34:35], v206 offset:1024
    ds_read_b128 v[16:19], v200
    ds_read_b128 v[20:23], v201
    ds_read_b128 v[24:27], v202
    ds_read_b128 v[28:31], v203
L_lwe_21:
    global_load_dwordx4 v[4:7], v216, s[8:9]
    global_load_dwordx2 v[12:13], v218, s[8:9] offset:16
    v_mov_b32 v51, v212
    v_mov_b32 v78, v11
    v_mov_b32 v11, v216
    v_mov_b32 v14, v217
    v_mov_b32 v10, v219
    v_mov_b32 v15, v220
    v_mov_b32 v9, v240
    v_mov_b32 v92, 0
    v_mov_b32 v93, 0
    v_mov_b32 v94, 0
    v_mov_b32 v95, 0
    v_mfma_f32_32x32x8bf16_1k v[144:159], v[92:93], v[92:93], 0
    v_mfma_f32_32x32x8bf16_1k v[160:175], v[92:93], v[92:93], 0
    v_mfma_f32_32x32x8bf16_1k v[176:191], v[92:93], v[92:93], 0
    v_mfma_f32_32x32x8bf16_1k v[192:207], v[92:93], v[92:93], 0
    v_mfma_f32_32x32x8bf16_1k v[208:223], v[92:93], v[92:93], 0
    s_setprio 2
    s_branch L_go
L_goB:
    s_mov_b32 s47, 1048576
L_lw_22:
    ds_read_b32 v134, v214
    s_waitcnt lgkmcnt(0)
    v_readfirstlane_b32 s63, v134
    s_nop 0
    s_cmp_ge_u32 s63, s45
    s_cbranch_scc1 L_lwr_23
    s_sub_u32 s47, s47, 1
    s_cbranch_scc0 L_lw_22
L_lwr_23:
    ds_read_b64 v[32:33], v204 offset:1024
    ds_read_b64 v[34:35], v206 offset:1024
    ds_read_b128 v[16:19], v200
    ds_read_b128 v[20:23], v201
    ds_read_b128 v[24:27], v202
    ds_read_b128 v[28:31], v203
L_lwe_24:
    v_mov_b32 v51, v212
    s_lshl_b32 s58, s39, 2
    s_add_u32 s58, s58, 160320
    v_mov_b32 v9, s58
    v_mov_b32 v92, 0
    v_mov_b32 v93, 0
    v_mov_b32 v94, 0
    v_mov_b32 v95, 0
    v_mfma_f32_32x32x8bf16_1k v[144:159], v[92:93], v[92:93], 0
    v_mfma_f32_32x32x8bf16_1k v[160:175], v[92:93], v[92:93], 0
    v_mfma_f32_32x32x8bf16_1k v[176:191], v[92:93], v[92:93], 0
    v_mfma_f32_32x32x8bf16_1k v[192:207], v[92:93], v[92:93], 0
    v_mfma_f32_32x32x8bf16_1k v[208:223], v[92:93], v[92:93], 0
    v_mov_b32 v4, 160312
    s_mov_b32 s47, 1048576
L_lw_25:
    ds_read_b32 v5, v4
    s_waitcnt lgkmcnt(0)
    v_readfirstlane_b32 s63, v5
    s_nop 0
    s_cmp_ge_u32 s63, 4
    s_cbranch_scc1 L_lwr_26
    s_sleep 1
    s_sub_u32 s47, s47, 1
    s_cbranch_scc0 L_lw_25
L_lwr_26:
L_lwe_27:
    s_mul_i32 s68, s39, 43008
    s_add_u32 s92, s68, 5376
    buffer_load_dwordx4 v[40:43], v240, s[48:51], s68 offen offset:0 sc1
    buffer_load_dwordx2 v[48:49], v241, s[48:51], s68 offen offset:2048 sc1
    buffer_load_dwordx4 v[52:55], v242, s[48:51], s68 offen offset:0 sc1
    buffer_load_dwordx4 v[56:59], v242, s[48:51], s68 offen offset:672 sc1
    buffer_load_dwordx4 v[44:47], v240, s[48:51], s68 offen offset:1024 sc1
    buffer_load_dwordx4 v[60:63], v242, s[48:51], s68 offen offset:1344 sc1
    buffer_load_dwordx4 v[64:67], v242, s[48:51], s68 offen offset:2016 sc1
    buffer_load_dwordx4 v[68:71], v240, s[48:51], s92 offen offset:0 sc1
    buffer_load_dwordx4 v[80:83], v242, s[48:51], s92 offen offset:0 sc1
    buffer_load_dwordx4 v[84:87], v242, s[48:51], s92 offen offset:672 sc1
    buffer_load_dwordx4 v[72:75], v240, s[48:51], s92 offen offset:1024 sc1
    buffer_load_dwordx2 v[76:77], v241, s[48:51], s92 offen offset:2048 sc1
    global_load_dwordx4 v[232:235], v230, s[8:9]
    global_load_dwordx2 v[236:237], v225, s[8:9] offset:16
    s_setprio 1
L_go:
    s_waitcnt vmcnt(9) lgkmcnt(0)
    v_mfma_f32_32x32x4_2b_bf16 v[96:127], v[48:49], v[32:33], 0 cbsz:1 abid:0
    s_mov_b32 s69, 0
    s_mov_b32 s59, s92
    s_add_u32 s60, s59, 5376
    v_mov_b32 v50, 160304
    v_mov_b32 v79, 1
    s_mov_b64 exec, 1
    ds_add_u32 v50, v79
    s_mov_b64 exec, -1
    s_bitcmp1_b32 s2, 0
    s_cselect_b64 s[4:5], s[22:23], s[30:31]
    s_cselect_b64 s[6:7], s[24:25], s[26:27]
    s_mov_b64 s[84:85], s[16:17]
    s_mov_b64 s[86:87], s[4:5]
    s_mov_b64 s[18:19], s[6:7]
    v_mov_b32 v36, -1
    v_mov_b32 v37, -1
    v_mov_b32 v38, -1
    v_mov_b32 v39, -1
    v_mfma_f32_32x32x16_bf16 v[96:111], v[40:43], v[16:19], v[96:111]
    v_mfma_f32_32x32x16_bf16 v[112:127], v[40:43], v[20:23], v[112:127]
    s_cmp_eq_u32 s40, 0
    s_nop 8
    s_cbranch_scc1 L_loop
.p2align 6
L_loopB:
    v_exp_f32 v96, v96
    v_exp_f32 v97, v97
    v_smfmac_f32_32x32x32_bf16 v[208:223], v[92:95], v[152:159], v243
    v_exp_f32 v98, v98
    v_exp_f32 v99, v99
    v_exp_f32 v100, v100
    v_mfma_f32_32x32x4_2b_bf16 v[128:159], v[48:49], v[34:35], 0 cbsz:1 abid:0
    v_exp_f32 v101, v101
    v_exp_f32 v102, v102
    v_exp_f32 v103, v103
    v_exp_f32 v104, v104
    v_exp_f32 v105, v105
    v_exp_f32 v106, v106
    v_exp_f32 v107, v107
    v_exp_f32 v108, v108
    v_smfmac_f32_32x32x32_bf16 v[160:175], v[52:55], v[96:103], v243
    v_exp_f32 v109, v109
    v_exp_f32 v110, v110
    v_exp_f32 v111, v111
    v_exp_f32 v112, v112
    v_exp_f32 v113, v113
    v_smfmac_f32_32x32x32_bf16 v[160:175], v[56:59], v[104:111], v243
    v_exp_f32 v114, v114
    v_exp_f32 v115, v115
    v_exp_f32 v116, v116
    v_mfma_f32_32x32x16_bf16 v[128:143], v[40:43], v[24:27], v[128:143]
    v_exp_f32 v117, v117
    v_exp_f32 v118, v118
    v_exp_f32 v119, v119
    v_exp_f32 v120, v120
    v_exp_f32 v121, v121
    v_smfmac_f32_32x32x32_bf16 v[176:191], v[52:55], v[112:119], v243
    v_exp_f32 v122, v122
    v_exp_f32 v123, v123
    v_exp_f32 v124, v124
    v_exp_f32 v125, v125
    v_mfma_f32_32x32x16_bf16 v[144:159], v[40:43], v[28:31], v[144:159]
    v_exp_f32 v126, v126
    v_exp_f32 v127, v127
    v_exp_f32 v128, v128
    v_exp_f32 v129, v129
    v_smfmac_f32_32x32x32_bf16 v[176:191], v[56:59], v[120:127], v243
    buffer_load_dwordx4 v[88:91], v242, s[48:51], s59 offen offset:1344 sc1
    buffer_load_dwordx4 v[92:95], v242, s[48:51], s59 offen offset:2016 sc1
    buffer_load_dwordx4 v[40:43], v240, s[48:51], s60 offen offset:0 sc1
    v_exp_f32 v130, v130
    v_exp_f32 v131, v131
    v_exp_f32 v132, v132
    v_mfma_f32_32x32x4_2b_bf16 v[96:127], v[48:49], v[32:33], 0 cbsz:1 abid:1
    v_exp_f32 v133, v133
    v_exp_f32 v134, v134
    v_exp_f32 v135, v135
    v_exp_f32 v136, v136
    v_exp_f32 v137, v137
    v_exp_f32 v138, v138
    v_exp_f32 v139, v139
    v_exp_f32 v140, v140
    v_smfmac_f32_32x32x32_bf16 v[192:207], v[52:55], v[128:135], v243
    v_exp_f32 v141, v141
    v_exp_f32 v142, v142
    v_exp_f32 v143, v143
    v_exp_f32 v144, v144
    v_exp_f32 v145, v145
    v_smfmac_f32_32x32x32_bf16 v[192:207], v[56:59], v[136:143], v243
    v_exp_f32 v146, v146
    v_exp_f32 v147, v147
    v_exp_f32 v148, v148
    v_mfma_f32_32x32x16_bf16 v[96:111], v[44:47], v[16:19], v[96:111]
    v_exp_f32 v149, v149
    v_exp_f32 v150, v150
    v_exp_f32 v151, v151
    v_exp_f32 v152, v152
    v_exp_f32 v153, v153
    v_smfmac_f32_32x32x32_bf16 v[208:223], v[52:55], v[144:151], v243
    v_exp_f32 v154, v154
    v_exp_f32 v155, v155
    v_exp_f32 v156, v156
    v_exp_f32 v157, v157
    v_mfma_f32_32x32x16_bf16 v[112:127], v[44:47], v[20:23], v[112:127]
    v_exp_f32 v158, v158
    v_exp_f32 v159, v159
    v_exp_f32 v96, v96
    v_exp_f32 v97, v97
    v_smfmac_f32_32x32x32_bf16 v[208:223], v[56:59], v[152:159], v243
    v_exp_f32 v98, v98
    v_exp_f32 v99, v99
    v_exp_f32 v100, v100
    v_mfma_f32_32x32x4_2b_bf16 v[128:159], v[48:49], v[34:35], 0 cbsz:1 abid:1
    v_exp_f32 v101, v101
    v_exp_f32 v102, v102
    v_exp_f32 v103, v103
    v_exp_f32 v104, v104
    v_exp_f32 v105, v105
    v_exp_f32 v106, v106
    v_exp_f32 v107, v107
    v_exp_f32 v108, v108
    s_waitcnt vmcnt(8)
    v_smfmac_f32_32x32x32_bf16 v[160:175], v[60:63], v[96:103], v243
    v_exp_f32 v109, v109
    v_exp_f32 v110, v110
    v_exp_f32 v111, v111
    v_exp_f32 v112, v112
    v_exp_f32 v113, v113
    v_smfmac_f32_32x32x32_bf16 v[160:175], v[64:67], v[104:111], v243
    v_exp_f32 v114, v114
    v_exp_f32 v115, v115
    v_exp_f32 v116, v116
    v_mfma_f32_32x32x16_bf16 v[128:143], v[44:47], v[24:27], v[128:143]
    v_exp_f32 v117, v117
    v_exp_f32 v118, v118
    v_exp_f32 v119, v119
    v_exp_f32 v120, v120
    v_exp_f32 v121, v121
    v_smfmac_f32_32x32x32_bf16 v[176:191], v[60:63], v[112:119], v243
    v_exp_f32 v122, v122
    v_exp_f32 v123, v123
    v_exp_f32 v124, v124
    v_exp_f32 v125, v125
    v_mfma_f32_32x32x16_bf16 v[144:159], v[44:47], v[28:31], v[144:159]
    v_exp_f32 v126, v126
    v_exp_f32 v127, v127
    v_exp_f32 v128, v128
    v_exp_f32 v129, v129
    v_smfmac_f32_32x32x32_bf16 v[176:191], v[64:67], v[120:127], v243
    s_waitcnt vmcnt(3)
    buffer_load_dwordx4 v[52:55], v242, s[48:51], s60 offen offset:0 sc1
    buffer_load_dwordx4 v[56:59], v242, s[48:51], s60 offen offset:672 sc1
    buffer_load_dwordx4 v[44:47], v240, s[48:51], s60 offen offset:1024 sc1
    buffer_load_dwordx2 v[48:49], v241, s[48:51], s60 offen offset:2048 sc1
    s_mov_b32 s59, s60
    s_add_u32 s60, s60, 5376
    v_exp_f32 v130, v130
    v_exp_f32 v131, v131
    v_exp_f32 v132, v132
    v_mfma_f32_32x32x4_2b_bf16 v[96:127], v[76:77], v[32:33], 0 cbsz:1 abid:0
    v_exp_f32 v133, v133
    v_exp_f32 v134, v134
    v_exp_f32 v135, v135
    v_exp_f32 v136, v136
    v_exp_f32 v137, v137
    v_exp_f32 v138, v138
    v_exp_f32 v139, v139
    v_exp_f32 v140, v140
    v_smfmac_f32_32x32x32_bf16 v[192:207], v[60:63], v[128:135], v243
    v_exp_f32 v141, v141
    v_exp_f32 v142, v142
    v_exp_f32 v143, v143
    v_exp_f32 v144, v144
    v_exp_f32 v145, v145
    v_smfmac_f32_32x32x32_bf16 v[192:207], v[64:67], v[136:143], v243
    v_exp_f32 v146, v146
    v_exp_f32 v147, v147
    v_exp_f32 v148, v148
    v_mfma_f32_32x32x16_bf16 v[96:111], v[68:71], v[16:19], v[96:111]
    v_exp_f32 v149, v149
    v_exp_f32 v150, v150
    v_exp_f32 v151, v151
    v_exp_f32 v152, v152
    v_exp_f32 v153, v153
    v_smfmac_f32_32x32x32_bf16 v[208:223], v[60:63], v[144:151], v243
    v_exp_f32 v154, v154
    v_exp_f32 v155, v155
    v_exp_f32 v156, v156
    v_exp_f32 v157, v157
    v_mfma_f32_32x32x16_bf16 v[112:127], v[68:71], v[20:23], v[112:127]
    v_exp_f32 v158, v158
    v_exp_f32 v159, v159
    v_exp_f32 v96, v96
    v_exp_f32 v97, v97
    v_smfmac_f32_32x32x32_bf16 v[208:223], v[64:67], v[152:159], v243
    v_exp_f32 v98, v98
    v_exp_f32 v99, v99
    v_exp_f32 v100, v100
    v_mfma_f32_32x32x4_2b_bf16 v[128:159], v[76:77], v[34:35], 0 cbsz:1 abid:0
    v_exp_f32 v101, v101
    v_exp_f32 v102, v102
    v_exp_f32 v103, v103
    v_exp_f32 v104, v104
    v_exp_f32 v105, v105
    v_exp_f32 v106, v106
    v_exp_f32 v107, v107
    v_exp_f32 v108, v108
    v_smfmac_f32_32x32x32_bf16 v[160:175], v[80:83], v[96:103], v243
    v_exp_f32 v109, v109
    v_exp_f32 v110, v110
    v_exp_f32 v111, v111
    v_exp_f32 v112, v112
    v_exp_f32 v113, v113
    v_smfmac_f32_32x32x32_bf16 v[160:175], v[84:87], v[104:111], v243
    v_exp_f32 v114, v114
    v_exp_f32 v115, v115
    v_exp_f32 v116, v116
    v_mfma_f32_32x32x16_bf16 v[128:143], v[68:71], v[24:27], v[128:143]
    v_exp_f32 v117, v117
    v_exp_f32 v118, v118
    v_exp_f32 v119, v119
    v_exp_f32 v120, v120
    v_exp_f32 v121, v121
    v_smfmac_f32_32x32x32_bf16 v[176:191], v[80:83], v[112:119], v243
    v_exp_f32 v122, v122
    v_exp_f32 v123, v123
    v_exp_f32 v124, v124
    v_exp_f32 v125, v125
    v_mfma_f32_32x32x16_bf16 v[144:159], v[68:71], v[28:31], v[144:159]
    v_exp_f32 v126, v126
    v_exp_f32 v127, v127
    v_exp_f32 v128, v128
    v_exp_f32 v129, v129
    v_smfmac_f32_32x32x32_bf16 v[176:191], v[84:87], v[120:127], v243
    buffer_load_dwordx4 v[60:63], v242, s[48:51], s59 offen offset:1344 sc1
    buffer_load_dwordx4 v[64:67], v242, s[48:51], s59 offen offset:2016 sc1
    buffer_load_dwordx4 v[68:71], v240, s[48:51], s60 offen offset:0 sc1
    v_exp_f32 v130, v130
    v_exp_f32 v131, v131
    v_exp_f32 v132, v132
    v_mfma_f32_32x32x4_2b_bf16 v[96:127], v[76:77], v[32:33], 0 cbsz:1 abid:1
    v_exp_f32 v133, v133
    v_exp_f32 v134, v134
    v_exp_f32 v135, v135
    v_exp_f32 v136, v136
    v_exp_f32 v137, v137
    v_exp_f32 v138, v138
    v_exp_f32 v139, v139
    v_exp_f32 v140, v140
    v_smfmac_f32_32x32x32_bf16 v[192:207], v[80:83], v[128:135], v243
    v_exp_f32 v141, v141
    v_exp_f32 v142, v142
    v_exp_f32 v143, v143
    v_exp_f32 v144, v144
    v_exp_f32 v145, v145
    v_smfmac_f32_32x32x32_bf16 v[192:207], v[84:87], v[136:143], v243
    v_exp_f32 v146, v146
    v_exp_f32 v147, v147
    v_exp_f32 v148, v148
    v_mfma_f32_32x32x16_bf16 v[96:111], v[72:75], v[16:19], v[96:111]
    v_exp_f32 v149, v149
    v_exp_f32 v150, v150
    v_exp_f32 v151, v151
    v_exp_f32 v152, v152
    v_exp_f32 v153, v153
    v_smfmac_f32_32x32x32_bf16 v[208:223], v[80:83], v[144:151], v243
    v_exp_f32 v154, v154
    v_exp_f32 v155, v155
    v_exp_f32 v156, v156
    v_exp_f32 v157, v157
    v_mfma_f32_32x32x16_bf16 v[112:127], v[72:75], v[20:23], v[112:127]
    v_exp_f32 v158, v158
    v_exp_f32 v159, v159
    v_exp_f32 v96, v96
    v_exp_f32 v97, v97
    v_smfmac_f32_32x32x32_bf16 v[208:223], v[84:87], v[152:159], v243
    v_exp_f32 v98, v98
    v_exp_f32 v99, v99
    v_exp_f32 v100, v100
    v_mfma_f32_32x32x4_2b_bf16 v[128:159], v[76:77], v[34:35], 0 cbsz:1 abid:1
    v_exp_f32 v101, v101
    v_exp_f32 v102, v102
    v_exp_f32 v103, v103
    v_exp_f32 v104, v104
    v_exp_f32 v105, v105
    v_exp_f32 v106, v106
    v_exp_f32 v107, v107
    v_exp_f32 v108, v108
    s_waitcnt vmcnt(8)
    v_smfmac_f32_32x32x32_bf16 v[160:175], v[88:91], v[96:103], v243
    v_exp_f32 v109, v109
    v_exp_f32 v110, v110
    v_exp_f32 v111, v111
    v_exp_f32 v112, v112
    v_exp_f32 v113, v113
    v_smfmac_f32_32x32x32_bf16 v[160:175], v[92:95], v[104:111], v243
    v_exp_f32 v114, v114
    v_exp_f32 v115, v115
    v_exp_f32 v116, v116
    v_mfma_f32_32x32x16_bf16 v[128:143], v[72:75], v[24:27], v[128:143]
    v_exp_f32 v117, v117
    v_exp_f32 v118, v118
    v_exp_f32 v119, v119
    v_exp_f32 v120, v120
    v_exp_f32 v121, v121
    v_smfmac_f32_32x32x32_bf16 v[176:191], v[88:91], v[112:119], v243
    v_exp_f32 v122, v122
    v_exp_f32 v123, v123
    v_exp_f32 v124, v124
    v_exp_f32 v125, v125
    v_mfma_f32_32x32x16_bf16 v[144:159], v[72:75], v[28:31], v[144:159]
    v_exp_f32 v126, v126
    v_exp_f32 v127, v127
    v_exp_f32 v128, v128
    v_exp_f32 v129, v129
    v_smfmac_f32_32x32x32_bf16 v[176:191], v[92:95], v[120:127], v243
    s_waitcnt vmcnt(3)
    buffer_load_dwordx4 v[80:83], v242, s[48:51], s60 offen offset:0 sc1
    buffer_load_dwordx4 v[84:87], v242, s[48:51], s60 offen offset:672 sc1
    buffer_load_dwordx4 v[72:75], v240, s[48:51], s60 offen offset:1024 sc1
    buffer_load_dwordx2 v[76:77], v241, s[48:51], s60 offen offset:2048 sc1
    s_mov_b32 s59, s60
    s_add_u32 s60, s60, 5376
    s_add_u32 s69, s69, 1
    s_cmp_lt_u32 s69, 3
    v_exp_f32 v130, v130
    v_exp_f32 v131, v131
    v_exp_f32 v132, v132
    v_mfma_f32_32x32x4_2b_bf16 v[96:127], v[48:49], v[32:33], 0 cbsz:1 abid:0
    v_exp_f32 v133, v133
    v_exp_f32 v134, v134
    v_exp_f32 v135, v135
    v_exp_f32 v136, v136
    v_exp_f32 v137, v137
    v_exp_f32 v138, v138
    v_exp_f32 v139, v139
    v_exp_f32 v140, v140
    v_smfmac_f32_32x32x32_bf16 v[192:207], v[88:91], v[128:135], v243
    v_exp_f32 v141, v141
    v_exp_f32 v142, v142
    v_exp_f32 v143, v143
    v_exp_f32 v144, v144
    v_exp_f32 v145, v145
    v_smfmac_f32_32x32x32_bf16 v[192:207], v[92:95], v[136:143], v243
    v_exp_f32 v146, v146
    v_exp_f32 v147, v147
    v_exp_f32 v148, v148
    v_mfma_f32_32x32x16_bf16 v[96:111], v[40:43], v[16:19], v[96:111]
    v_exp_f32 v149, v149
    v_exp_f32 v150, v150
    v_exp_f32 v151, v151
    v_exp_f32 v152, v152
    v_exp_f32 v153, v153
    v_smfmac_f32_32x32x32_bf16 v[208:223], v[88:91], v[144:151], v243
    v_exp_f32 v154, v154
    v_exp_f32 v155, v155
    v_exp_f32 v156, v156
    v_exp_f32 v157, v157
    v_mfma_f32_32x32x16_bf16 v[112:127], v[40:43], v[20:23], v[112:127]
    v_exp_f32 v158, v158
    v_exp_f32 v159, v159
    s_cbranch_scc1 L_loopB
    global_load_dwordx2 v[228:229], v224, s[36:37] sc1
    s_branch L_peel
.p2align 6
L_loop:
    v_exp_f32 v96, v96
    v_exp_f32 v97, v97
    v_smfmac_f32_32x32x32_bf16 v[208:223], v[92:95], v[152:159], v243
    v_exp_f32 v98, v98
    v_exp_f32 v99, v99
    v_exp_f32 v100, v100
    v_mfma_f32_32x32x4_2b_bf16 v[128:159], v[48:49], v[34:35], 0 cbsz:1 abid:0
    v_exp_f32 v101, v101
    v_exp_f32 v102, v102
    v_exp_f32 v103, v103
    v_exp_f32 v104, v104
    v_exp_f32 v105, v105
    v_exp_f32 v106, v106
    v_exp_f32 v107, v107
    v_exp_f32 v108, v108
    v_smfmac_f32_32x32x32_bf16 v[160:175], v[52:55], v[96:103], v243
    v_exp_f32 v109, v109
    v_exp_f32 v110, v110
    v_exp_f32 v111, v111
    v_exp_f32 v112, v112
    v_exp_f32 v113, v113
    v_smfmac_f32_32x32x32_bf16 v[160:175], v[56:59], v[104:111], v243
    buffer_load_dwordx4 v[88:91], v242, s[48:51], s59 offen offset:1344 sc1
    buffer_load_dwordx4 v[92:95], v242, s[48:51], s59 offen offset:2016 sc1
    v_exp_f32 v114, v114
    v_exp_f32 v115, v115
    v_exp_f32 v116, v116
    v_mfma_f32_32x32x16_bf16 v[128:143], v[40:43], v[24:27], v[128:143]
    v_exp_f32 v117, v117
    v_exp_f32 v118, v118
    v_exp_f32 v119, v119
    v_exp_f32 v120, v120
    v_exp_f32 v121, v121
    v_smfmac_f32_32x32x32_bf16 v[176:191], v[52:55], v[112:119], v243
    v_exp_f32 v122, v122
    v_exp_f32 v123, v123
    v_exp_f32 v124, v124
    v_exp_f32 v125, v125
    v_mfma_f32_32x32x16_bf16 v[144:159], v[40:43], v[28:31], v[144:159]
    v_exp_f32 v126, v126
    v_exp_f32 v127, v127
    v_exp_f32 v128, v128
    v_exp_f32 v129, v129
    v_smfmac_f32_32x32x32_bf16 v[176:191], v[56:59], v[120:127], v243
    buffer_load_dwordx4 v[40:43], v240, s[48:51], s60 offen offset:0 sc1
    v_exp_f32 v130, v130
    v_exp_f32 v131, v131
    v_exp_f32 v132, v132
    v_mfma_f32_32x32x4_2b_bf16 v[96:127], v[48:49], v[32:33], 0 cbsz:1 abid:1
    v_exp_f32 v133, v133
    v_exp_f32 v134, v134
    v_exp_f32 v135, v135
    v_exp_f32 v136, v136
    v_exp_f32 v137, v137
    v_exp_f32 v138, v138
    v_exp_f32 v139, v139
    v_exp_f32 v140, v140
    v_smfmac_f32_32x32x32_bf16 v[192:207], v[52:55], v[128:135], v243
    v_exp_f32 v141, v141
    v_exp_f32 v142, v142
    v_exp_f32 v143, v143
    v_exp_f32 v144, v144
    v_exp_f32 v145, v145
    v_smfmac_f32_32x32x32_bf16 v[192:207], v[56:59], v[136:143], v243
    buffer_load_dword v50, v78, s[48:51], 0 offen sc1
    global_store_dwordx4 v231, v[36:39], s[36:37] sc1
    v_exp_f32 v146, v146
    v_exp_f32 v147, v147
    v_exp_f32 v148, v148
    v_mfma_f32_32x32x16_bf16 v[96:111], v[44:47], v[16:19], v[96:111]
    v_exp_f32 v149, v149
    v_exp_f32 v150, v150
    v_exp_f32 v151, v151
    v_exp_f32 v152, v152
    v_exp_f32 v153, v153
    v_smfmac_f32_32x32x32_bf16 v[208:223], v[52:55], v[144:151], v243
    v_exp_f32 v154, v154
    v_exp_f32 v155, v155
    v_exp_f32 v156, v156
    v_exp_f32 v157, v157
    v_mfma_f32_32x32x16_bf16 v[112:127], v[44:47], v[20:23], v[112:127]
    v_exp_f32 v158, v158
    v_exp_f32 v159, v159
    v_exp_f32 v96, v96
    v_exp_f32 v97, v97
    v_smfmac_f32_32x32x32_bf16 v[208:223], v[56:59], v[152:159], v243
    v_exp_f32 v98, v98
    v_exp_f32 v99, v99
    v_exp_f32 v100, v100
    v_mfma_f32_32x32x4_2b_bf16 v[128:159], v[48:49], v[34:35], 0 cbsz:1 abid:1
    v_exp_f32 v101, v101
    v_exp_f32 v102, v102
    v_exp_f32 v103, v103
    v_exp_f32 v104, v104
    v_exp_f32 v105, v105
    v_exp_f32 v106, v106
    v_exp_f32 v107, v107
    v_exp_f32 v108, v108
    s_waitcnt vmcnt(11)
    v_smfmac_f32_32x32x32_bf16 v[160:175], v[60:63], v[96:103], v243
    v_exp_f32 v109, v109
    v_exp_f32 v110, v110
    v_exp_f32 v111, v111
    v_exp_f32 v112, v112
    v_exp_f32 v113, v113
    v_smfmac_f32_32x32x32_bf16 v[160:175], v[64:67], v[104:111], v243
    buffer_load_dwordx4 v[52:55], v242, s[48:51], s60 offen offset:0 sc1
    buffer_load_dwordx4 v[56:59], v242, s[48:51], s60 offen offset:672 sc1
    v_exp_f32 v114, v114
    v_exp_f32 v115, v115
    v_exp_f32 v116, v116
    v_mfma_f32_32x32x16_bf16 v[128:143], v[44:47], v[24:27], v[128:143]
    v_exp_f32 v117, v117
    v_exp_f32 v118, v118
    v_exp_f32 v119, v119
    v_exp_f32 v120, v120
    v_exp_f32 v121, v121
    v_smfmac_f32_32x32x32_bf16 v[176:191], v[60:63], v[112:119], v243
    v_exp_f32 v122, v122
    v_exp_f32 v123, v123
    v_exp_f32 v124, v124
    v_exp_f32 v125, v125
    v_mfma_f32_32x32x16_bf16 v[144:159], v[44:47], v[28:31], v[144:159]
    v_exp_f32 v126, v126
    v_exp_f32 v127, v127
    v_exp_f32 v128, v128
    v_exp_f32 v129, v129
    v_smfmac_f32_32x32x32_bf16 v[176:191], v[64:67], v[120:127], v243
    s_waitcnt vmcnt(8)
    buffer_load_dwordx4 v[44:47], v240, s[48:51], s60 offen offset:1024 sc1
    buffer_load_dwordx2 v[48:49], v241, s[48:51], s60 offen offset:2048 sc1
    global_load_dword v50, v224, s[84:85]
    v_exp_f32 v130, v130
    v_exp_f32 v131, v131
    v_exp_f32 v132, v132
    v_mfma_f32_32x32x4_2b_bf16 v[96:127], v[76:77], v[32:33], 0 cbsz:1 abid:0
    v_exp_f32 v133, v133
    v_exp_f32 v134, v134
    v_exp_f32 v135, v135
    v_exp_f32 v136, v136
    v_exp_f32 v137, v137
    v_exp_f32 v138, v138
    v_exp_f32 v139, v139
    v_exp_f32 v140, v140
    v_mov_b32 v224, v225
    v_mov_b32 v225, v226
    s_mov_b64 s[84:85], s[86:87]
    s_mov_b64 s[86:87], s[18:19]
    v_smfmac_f32_32x32x32_bf16 v[192:207], v[60:63], v[128:135], v243
    v_exp_f32 v141, v141
    v_exp_f32 v142, v142
    v_exp_f32 v143, v143
    v_exp_f32 v144, v144
    v_exp_f32 v145, v145
    v_smfmac_f32_32x32x32_bf16 v[192:207], v[64:67], v[136:143], v243
    s_mov_b32 s59, s60
    s_add_u32 s60, s60, 5376
    v_exp_f32 v146, v146
    v_exp_f32 v147, v147
    v_exp_f32 v148, v148
    v_mfma_f32_32x32x16_bf16 v[96:111], v[68:71], v[16:19], v[96:111]
    v_exp_f32 v149, v149
    v_exp_f32 v150, v150
    v_exp_f32 v151, v151
    v_exp_f32 v152, v152
    v_exp_f32 v153, v153
    v_smfmac_f32_32x32x32_bf16 v[208:223], v[60:63], v[144:151], v243
    v_exp_f32 v154, v154
    v_exp_f32 v155, v155
    v_exp_f32 v156, v156
    v_exp_f32 v157, v157
    v_mfma_f32_32x32x16_bf16 v[112:127], v[68:71], v[20:23], v[112:127]
    v_exp_f32 v158, v158
    v_exp_f32 v159, v159
    v_exp_f32 v96, v96
    v_exp_f32 v97, v97
    v_smfmac_f32_32x32x32_bf16 v[208:223], v[64:67], v[152:159], v243
    v_exp_f32 v98, v98
    v_exp_f32 v99, v99
    v_exp_f32 v100, v100
    v_mfma_f32_32x32x4_2b_bf16 v[128:159], v[76:77], v[34:35], 0 cbsz:1 abid:0
    v_exp_f32 v101, v101
    v_exp_f32 v102, v102
    v_exp_f32 v103, v103
    v_exp_f32 v104, v104
    v_exp_f32 v105, v105
    v_exp_f32 v106, v106
    v_exp_f32 v107, v107
    v_exp_f32 v108, v108
    v_smfmac_f32_32x32x32_bf16 v[160:175], v[80:83], v[96:103], v243
    v_exp_f32 v109, v109
    v_exp_f32 v110, v110
    v_exp_f32 v111, v111
    v_exp_f32 v112, v112
    v_exp_f32 v113, v113
    v_smfmac_f32_32x32x32_bf16 v[160:175], v[84:87], v[104:111], v243
    buffer_load_dwordx4 v[60:63], v242, s[48:51], s59 offen offset:1344 sc1
    buffer_load_dwordx4 v[64:67], v242, s[48:51], s59 offen offset:2016 sc1
    v_exp_f32 v114, v114
    v_exp_f32 v115, v115
    v_exp_f32 v116, v116
    v_mfma_f32_32x32x16_bf16 v[128:143], v[68:71], v[24:27], v[128:143]
    v_exp_f32 v117, v117
    v_exp_f32 v118, v118
    v_exp_f32 v119, v119
    v_exp_f32 v120, v120
    v_exp_f32 v121, v121
    v_smfmac_f32_32x32x32_bf16 v[176:191], v[80:83], v[112:119], v243
    v_exp_f32 v122, v122
    v_exp_f32 v123, v123
    v_exp_f32 v124, v124
    v_exp_f32 v125, v125
    v_mfma_f32_32x32x16_bf16 v[144:159], v[68:71], v[28:31], v[144:159]
    v_exp_f32 v126, v126
    v_exp_f32 v127, v127
    v_exp_f32 v128, v128
    v_exp_f32 v129, v129
    v_smfmac_f32_32x32x32_bf16 v[176:191], v[84:87], v[120:127], v243
    buffer_load_dwordx4 v[68:71], v240, s[48:51], s60 offen offset:0 sc1
    v_exp_f32 v130, v130
    v_exp_f32 v131, v131
    v_exp_f32 v132, v132
    v_mfma_f32_32x32x4_2b_bf16 v[96:127], v[76:77], v[32:33], 0 cbsz:1 abid:1
    v_exp_f32 v133, v133
    v_exp_f32 v134, v134
    v_exp_f32 v135, v135
    v_exp_f32 v136, v136
    v_exp_f32 v137, v137
    v_exp_f32 v138, v138
    v_exp_f32 v139, v139
    v_exp_f32 v140, v140
    v_smfmac_f32_32x32x32_bf16 v[192:207], v[80:83], v[128:135], v243
    v_exp_f32 v141, v141
    v_exp_f32 v142, v142
    v_exp_f32 v143, v143
    v_exp_f32 v144, v144
    v_exp_f32 v145, v145
    v_smfmac_f32_32x32x32_bf16 v[192:207], v[84:87], v[136:143], v243
    buffer_store_dwordx4 v[36:39], v230, s[48:51], 0 offen sc1
    v_exp_f32 v146, v146
    v_exp_f32 v147, v147
    v_exp_f32 v148, v148
    v_mfma_f32_32x32x16_bf16 v[96:111], v[72:75], v[16:19], v[96:111]
    v_exp_f32 v149, v149
    v_exp_f32 v150, v150
    v_exp_f32 v151, v151
    v_exp_f32 v152, v152
    v_exp_f32 v153, v153
    v_add_u32 v230, 384, v230
    v_smfmac_f32_32x32x32_bf16 v[208:223], v[80:83], v[144:151], v243
    v_exp_f32 v154, v154
    v_exp_f32 v155, v155
    v_exp_f32 v156, v156
    v_exp_f32 v157, v157
    v_mfma_f32_32x32x16_bf16 v[112:127], v[72:75], v[20:23], v[112:127]
    v_exp_f32 v158, v158
    v_exp_f32 v159, v159
    v_exp_f32 v96, v96
    v_exp_f32 v97, v97
    v_smfmac_f32_32x32x32_bf16 v[208:223], v[84:87], v[152:159], v243
    v_exp_f32 v98, v98
    v_exp_f32 v99, v99
    v_exp_f32 v100, v100
    v_mfma_f32_32x32x4_2b_bf16 v[128:159], v[76:77], v[34:35], 0 cbsz:1 abid:1
    v_exp_f32 v101, v101
    v_exp_f32 v102, v102
    v_exp_f32 v103, v103
    v_exp_f32 v104, v104
    v_exp_f32 v105, v105
    v_exp_f32 v106, v106
    v_exp_f32 v107, v107
    v_exp_f32 v108, v108
    s_waitcnt vmcnt(12)
    v_smfmac_f32_32x32x32_bf16 v[160:175], v[88:91], v[96:103], v243
    v_exp_f32 v109, v109
    v_exp_f32 v110, v110
    v_exp_f32 v111, v111
    v_exp_f32 v112, v112
    v_exp_f32 v113, v113
    v_smfmac_f32_32x32x32_bf16 v[160:175], v[92:95], v[104:111], v243
    buffer_load_dwordx4 v[80:83], v242, s[48:51], s60 offen offset:0 sc1
    buffer_load_dwordx4 v[84:87], v242, s[48:51], s60 offen offset:672 sc1
    v_exp_f32 v114, v114
    v_exp_f32 v115, v115
    v_exp_f32 v116, v116
    v_mfma_f32_32x32x16_bf16 v[128:143], v[72:75], v[24:27], v[128:143]
    v_exp_f32 v117, v117
    v_exp_f32 v118, v118
    v_exp_f32 v119, v119
    v_exp_f32 v120, v120
    v_exp_f32 v121, v121
    v_smfmac_f32_32x32x32_bf16 v[176:191], v[88:91], v[112:119], v243
    v_exp_f32 v122, v122
    v_exp_f32 v123, v123
    v_exp_f32 v124, v124
    v_exp_f32 v125, v125
    v_mfma_f32_32x32x16_bf16 v[144:159], v[72:75], v[28:31], v[144:159]
    v_exp_f32 v126, v126
    v_exp_f32 v127, v127
    v_exp_f32 v128, v128
    v_exp_f32 v129, v129
    v_smfmac_f32_32x32x32_bf16 v[176:191], v[92:95], v[120:127], v243
    s_waitcnt vmcnt(7)
    buffer_load_dwordx4 v[72:75], v240, s[48:51], s60 offen offset:1024 sc1
    buffer_load_dwordx2 v[76:77], v241, s[48:51], s60 offen offset:2048 sc1
    global_load_dword v50, v227, s[4:5]
    v_exp_f32 v130, v130
    v_exp_f32 v131, v131
    v_exp_f32 v132, v132
    v_mfma_f32_32x32x4_2b_bf16 v[96:127], v[48:49], v[32:33], 0 cbsz:1 abid:0
    v_exp_f32 v133, v133
    v_exp_f32 v134, v134
    v_exp_f32 v135, v135
    v_exp_f32 v136, v136
    v_exp_f32 v137, v137
    v_exp_f32 v138, v138
    v_exp_f32 v139, v139
    v_exp_f32 v140, v140
    v_mov_b32 v227, v228
    v_mov_b32 v228, v229
    s_mov_b64 s[4:5], s[6:7]
    s_mov_b64 s[6:7], s[20:21]
    v_smfmac_f32_32x32x32_bf16 v[192:207], v[88:91], v[128:135], v243
    v_exp_f32 v141, v141
    v_exp_f32 v142, v142
    v_exp_f32 v143, v143
    v_exp_f32 v144, v144
    v_exp_f32 v145, v145
    v_smfmac_f32_32x32x32_bf16 v[192:207], v[92:95], v[136:143], v243
    s_mov_b32 s59, s60
    s_add_u32 s60, s60, 5376
    s_add_u32 s69, s69, 1
    s_cmp_lt_u32 s69, 3
    v_exp_f32 v146, v146
    v_exp_f32 v147, v147
    v_exp_f32 v148, v148
    v_mfma_f32_32x32x16_bf16 v[96:111], v[40:43], v[16:19], v[96:111]
    v_exp_f32 v149, v149
    v_exp_f32 v150, v150
    v_exp_f32 v151, v151
    v_exp_f32 v152, v152
    v_exp_f32 v153, v153
    v_smfmac_f32_32x32x32_bf16 v[208:223], v[88:91], v[144:151], v243
    v_exp_f32 v154, v154
    v_exp_f32 v155, v155
    v_exp_f32 v156, v156
    v_exp_f32 v157, v157
    v_mfma_f32_32x32x16_bf16 v[112:127], v[40:43], v[20:23], v[112:127]
    v_exp_f32 v158, v158
    v_exp_f32 v159, v159
    s_cbranch_scc1 L_loop
L_peel:
    v_exp_f32 v96, v96
    v_exp_f32 v97, v97
    v_smfmac_f32_32x32x32_bf16 v[208:223], v[92:95], v[152:159], v243
    v_exp_f32 v98, v98
    v_exp_f32 v99, v99
    v_exp_f32 v100, v100
    v_mfma_f32_32x32x4_2b_bf16 v[128:159], v[48:49], v[34:35], 0 cbsz:1 abid:0
    v_exp_f32 v101, v101
    v_exp_f32 v102, v102
    v_exp_f32 v103, v103
    v_exp_f32 v104, v104
    v_exp_f32 v105, v105
    v_exp_f32 v106, v106
    v_exp_f32 v107, v107
    v_exp_f32 v108, v108
    v_smfmac_f32_32x32x32_bf16 v[160:175], v[52:55], v[96:103], v243
    v_exp_f32 v109, v109
    v_exp_f32 v110, v110
    v_exp_f32 v111, v111
    v_exp_f32 v112, v112
    v_exp_f32 v113, v113
    v_smfmac_f32_32x32x32_bf16 v[160:175], v[56:59], v[104:111], v243
    buffer_load_dwordx4 v[88:91], v242, s[48:51], s59 offen offset:1344 sc1
    buffer_load_dwordx4 v[92:95], v242, s[48:51], s59 offen offset:2016 sc1
    global_load_dwordx2 v[78:79], v51, s[36:37] sc1
    v_exp_f32 v114, v114
    v_exp_f32 v115, v115
    v_exp_f32 v116, v116
    v_mfma_f32_32x32x16_bf16 v[128:143], v[40:43], v[24:27], v[128:143]
    v_exp_f32 v117, v117
    v_exp_f32 v118, v118
    v_exp_f32 v119, v119
    v_exp_f32 v120, v120
    v_exp_f32 v121, v121
    v_smfmac_f32_32x32x32_bf16 v[176:191], v[52:55], v[112:119], v243
    v_exp_f32 v122, v122
    v_exp_f32 v123, v123
    v_exp_f32 v124, v124
    v_exp_f32 v125, v125
    v_mfma_f32_32x32x16_bf16 v[144:159], v[40:43], v[28:31], v[144:159]
    v_exp_f32 v126, v126
    v_exp_f32 v127, v127
    v_exp_f32 v128, v128
    v_exp_f32 v129, v129
    v_smfmac_f32_32x32x32_bf16 v[176:191], v[56:59], v[120:127], v243
    s_mov_b32 s61, 160268
    v_exp_f32 v130, v130
    v_exp_f32 v131, v131
    v_exp_f32 v132, v132
    v_mfma_f32_32x32x4_2b_bf16 v[96:127], v[48:49], v[32:33], 0 cbsz:1 abid:1
    v_exp_f32 v133, v133
    v_exp_f32 v134, v134
    v_exp_f32 v135, v135
    v_exp_f32 v136, v136
    v_exp_f32 v137, v137
    v_exp_f32 v138, v138
    v_exp_f32 v139, v139
    v_exp_f32 v140, v140
    v_smfmac_f32_32x32x32_bf16 v[192:207], v[52:55], v[128:135], v243
    v_exp_f32 v141, v141
    v_exp_f32 v142, v142
    v_exp_f32 v143, v143
    v_exp_f32 v144, v144
    v_exp_f32 v145, v145
    v_smfmac_f32_32x32x32_bf16 v[192:207], v[56:59], v[136:143], v243
    s_cmp_eq_u32 s40, 0
    s_cselect_b32 s58, 160304, s61
    s_cselect_b32 s61, 8, 4
    v_mov_b32 v224, s58
    ds_read_b32 v225, v224
    v_exp_f32 v146, v146
    v_exp_f32 v147, v147
    v_exp_f32 v148, v148
    v_mfma_f32_32x32x16_bf16 v[96:111], v[44:47], v[16:19], v[96:111]
    v_exp_f32 v149, v149
    v_exp_f32 v150, v150
    v_exp_f32 v151, v151
    v_exp_f32 v152, v152
    v_exp_f32 v153, v153
    v_smfmac_f32_32x32x32_bf16 v[208:223], v[52:55], v[144:151], v243
    v_exp_f32 v154, v154
    v_exp_f32 v155, v155
    v_exp_f32 v156, v156
    v_exp_f32 v157, v157
    v_mfma_f32_32x32x16_bf16 v[112:127], v[44:47], v[20:23], v[112:127]
    v_exp_f32 v158, v158
    v_exp_f32 v159, v159
    v_exp_f32 v96, v96
    v_exp_f32 v97, v97
    v_smfmac_f32_32x32x32_bf16 v[208:223], v[56:59], v[152:159], v243
    v_exp_f32 v98, v98
    v_exp_f32 v99, v99
    v_exp_f32 v100, v100
    v_mfma_f32_32x32x4_2b_bf16 v[128:159], v[48:49], v[34:35], 0 cbsz:1 abid:1
    v_exp_f32 v101, v101
    v_exp_f32 v102, v102
    v_exp_f32 v103, v103
    v_exp_f32 v104, v104
    v_exp_f32 v105, v105
    v_exp_f32 v106, v106
    v_exp_f32 v107, v107
    v_exp_f32 v108, v108
    s_waitcnt vmcnt(8)
    v_smfmac_f32_32x32x32_bf16 v[160:175], v[60:63], v[96:103], v243
    v_exp_f32 v109, v109
    v_exp_f32 v110, v110
    v_exp_f32 v111, v111
    v_exp_f32 v112, v112
    v_exp_f32 v113, v113
    v_smfmac_f32_32x32x32_bf16 v[160:175], v[64:67], v[104:111], v243
    v_exp_f32 v114, v114
    v_exp_f32 v115, v115
    v_exp_f32 v116, v116
    v_mfma_f32_32x32x16_bf16 v[128:143], v[44:47], v[24:27], v[128:143]
    v_exp_f32 v117, v117
    v_exp_f32 v118, v118
    v_exp_f32 v119, v119
    v_exp_f32 v120, v120
    v_exp_f32 v121, v121
    v_smfmac_f32_32x32x32_bf16 v[176:191], v[60:63], v[112:119], v243
    v_exp_f32 v122, v122
    v_exp_f32 v123, v123
    v_exp_f32 v124, v124
    v_exp_f32 v125, v125
    v_mfma_f32_32x32x16_bf16 v[144:159], v[44:47], v[28:31], v[144:159]
    v_exp_f32 v126, v126
    v_exp_f32 v127, v127
    s_waitcnt vmcnt(0) lgkmcnt(0)
    v_readfirstlane_b32 s63, v225
    s_nop 0
    s_cmp_ge_u32 s63, s61
    s_cbranch_scc1 L_free
    s_mov_b32 s47, 1048576
L_lw_28:
    ds_read_b32 v225, v224
    s_waitcnt lgkmcnt(0)
    v_readfirstlane_b32 s63, v225
    s_nop 0
    s_cmp_ge_u32 s63, s61
    s_cbranch_scc1 L_lwr_29
    s_sleep 2
    s_sub_u32 s47, s47, 1
    s_cbranch_scc0 L_lw_28
L_lwr_29:
L_lwe_30:
L_free:
    v_cmp_ne_u32 vcc, s43, v78
    s_nop 0
    s_cbranch_vccz L_peers
    s_mov_b32 s47, 131072
L_pm_31:
    global_load_dwordx2 v[78:79], v51, s[36:37] sc1
    s_waitcnt vmcnt(0)
    v_cmp_ne_u32 vcc, s43, v78
    s_nop 0
    s_cbranch_vccz L_pme_32
    s_mov_b64 exec, vcc
    s_sub_u32 s47, s47, 1
    s_cbranch_scc0 L_pm_31
L_pme_32:
    s_mov_b64 exec, -1
L_peers:
    v_cmp_ne_u32 vcc, v239, v79
    s_nop 0
    s_cmp_eq_u64 vcc, 0
    s_cselect_b32 s91, 1, 0
    s_add_u32 s45, s45, 4
    v_mov_b32 v226, s72
    v_mov_b32 v227, 1
    s_cmp_lg_u32 s40, 0
    s_cbranch_scc1 L_lastB
    s_mul_i32 s58, s39, 204800
    s_mul_i32 s59, s42, 160
    s_add_u32 s58, s58, s59
    s_add_u32 s52, s16, s58
    s_addc_u32 s53, s17, 0
    s_mul_i32 s60, s39, 25600
    s_add_u32 m0, s60, 2048
    s_nop 0
    global_load_lds_dwordx4 v234, s[52:53]
    v_exp_f32 v128, v128
    v_exp_f32 v129, v129
    v_smfmac_f32_32x32x32_bf16 v[176:191], v[64:67], v[120:127], v243
    s_add_u32 m0, s60, 0
    s_nop 0
    global_load_lds_dwordx4 v232, s[52:53]
    v_exp_f32 v130, v130
    v_exp_f32 v131, v131
    v_exp_f32 v132, v132
    v_mfma_f32_32x32x4_2b_bf16 v[96:127], v[76:77], v[32:33], 0 cbsz:1 abid:0
    v_exp_f32 v133, v133
    v_exp_f32 v134, v134
    v_exp_f32 v135, v135
    v_exp_f32 v136, v136
    v_exp_f32 v137, v137
    v_exp_f32 v138, v138
    v_exp_f32 v139, v139
    v_exp_f32 v140, v140
    s_add_u32 m0, s60, 1024
    s_nop 0
    global_load_lds_dwordx4 v233, s[52:53]
    v_smfmac_f32_32x32x32_bf16 v[192:207], v[60:63], v[128:135], v243
    v_exp_f32 v141, v141
    v_exp_f32 v142, v142
    v_exp_f32 v143, v143
    v_exp_f32 v144, v144
    v_exp_f32 v145, v145
    v_smfmac_f32_32x32x32_bf16 v[192:207], v[64:67], v[136:143], v243
    s_add_u32 m0, s60, 3072
    s_nop 0
    global_load_lds_dwordx4 v235, s[52:53]
    v_exp_f32 v146, v146
    v_exp_f32 v147, v147
    v_exp_f32 v148, v148
    v_mfma_f32_32x32x16_bf16 v[96:111], v[68:71], v[16:19], v[96:111]
    v_exp_f32 v149, v149
    v_exp_f32 v150, v150
    v_exp_f32 v151, v151
    v_exp_f32 v152, v152
    v_exp_f32 v153, v153
    s_add_u32 m0, s60, 4096
    s_nop 0
    global_load_lds_dwordx4 v236, s[52:53]
    s_add_u32 s52, s52, 40960
    s_addc_u32 s53, s53, 0
    v_smfmac_f32_32x32x32_bf16 v[208:223], v[60:63], v[144:151], v243
    v_exp_f32 v154, v154
    v_exp_f32 v155, v155
    v_exp_f32 v156, v156
    v_exp_f32 v157, v157
    v_mfma_f32_32x32x16_bf16 v[112:127], v[68:71], v[20:23], v[112:127]
    v_exp_f32 v158, v158
    v_exp_f32 v159, v159
    s_add_u32 m0, s60, 7168
    s_nop 0
    global_load_lds_dwordx4 v234, s[52:53]
    v_exp_f32 v96, v96
    v_exp_f32 v97, v97
    v_smfmac_f32_32x32x32_bf16 v[208:223], v[64:67], v[152:159], v243
    s_add_u32 m0, s60, 5120
    s_nop 0
    global_load_lds_dwordx4 v232, s[52:53]
    v_exp_f32 v98, v98
    v_exp_f32 v99, v99
    v_exp_f32 v100, v100
    v_mfma_f32_32x32x4_2b_bf16 v[128:159], v[76:77], v[34:35], 0 cbsz:1 abid:0
    v_exp_f32 v101, v101
    v_exp_f32 v102, v102
    v_exp_f32 v103, v103
    v_exp_f32 v104, v104
    v_exp_f32 v105, v105
    v_exp_f32 v106, v106
    v_exp_f32 v107, v107
    v_exp_f32 v108, v108
    s_add_u32 m0, s60, 6144
    s_nop 0
    global_load_lds_dwordx4 v233, s[52:53]
    v_smfmac_f32_32x32x32_bf16 v[160:175], v[80:83], v[96:103], v243
    v_exp_f32 v109, v109
    v_exp_f32 v110, v110
    v_exp_f32 v111, v111
    v_exp_f32 v112, v112
    v_exp_f32 v113, v113
    v_smfmac_f32_32x32x32_bf16 v[160:175], v[84:87], v[104:111], v243
    s_add_u32 m0, s60, 8192
    s_nop 0
    global_load_lds_dwordx4 v235, s[52:53]
    v_exp_f32 v114, v114
    v_exp_f32 v115, v115
    v_exp_f32 v116, v116
    v_mfma_f32_32x32x16_bf16 v[128:143], v[68:71], v[24:27], v[128:143]
    v_exp_f32 v117, v117
    v_exp_f32 v118, v118
    v_exp_f32 v119, v119
    v_exp_f32 v120, v120
    v_exp_f32 v121, v121
    s_add_u32 m0, s60, 9216
    s_nop 0
    global_load_lds_dwordx4 v236, s[52:53]
    s_add_u32 s52, s52, 40960
    s_addc_u32 s53, s53, 0
    v_smfmac_f32_32x32x32_bf16 v[176:191], v[80:83], v[112:119], v243
    v_exp_f32 v122, v122
    v_exp_f32 v123, v123
    v_exp_f32 v124, v124
    v_exp_f32 v125, v125
    v_mfma_f32_32x32x16_bf16 v[144:159], v[68:71], v[28:31], v[144:159]
    v_exp_f32 v126, v126
    v_exp_f32 v127, v127
    s_add_u32 m0, s60, 12288
    s_nop 0
    global_load_lds_dwordx4 v234, s[52:53]
    v_exp_f32 v128, v128
    v_exp_f32 v129, v129
    v_smfmac_f32_32x32x32_bf16 v[176:191], v[84:87], v[120:127], v243
    s_add_u32 m0, s60, 10240
    s_nop 0
    global_load_lds_dwordx4 v232, s[52:53]
    v_exp_f32 v130, v130
    v_exp_f32 v131, v131
    v_exp_f32 v132, v132
    v_mfma_f32_32x32x4_2b_bf16 v[96:127], v[76:77], v[32:33], 0 cbsz:1 abid:1
    v_exp_f32 v133, v133
    v_exp_f32 v134, v134
    v_exp_f32 v135, v135
    v_exp_f32 v136, v136
    v_exp_f32 v137, v137
    v_exp_f32 v138, v138
    v_exp_f32 v139, v139
    v_exp_f32 v140, v140
    s_add_u32 m0, s60, 11264
    s_nop 0
    global_load_lds_dwordx4 v233, s[52:53]
    v_smfmac_f32_32x32x32_bf16 v[192:207], v[80:83], v[128:135], v243
    v_exp_f32 v141, v141
    v_exp_f32 v142, v142
    v_exp_f32 v143, v143
    v_exp_f32 v144, v144
    v_exp_f32 v145, v145
    v_smfmac_f32_32x32x32_bf16 v[192:207], v[84:87], v[136:143], v243
    s_add_u32 m0, s60, 13312
    s_nop 0
    global_load_lds_dwordx4 v235, s[52:53]
    v_exp_f32 v146, v146
    v_exp_f32 v147, v147
    v_exp_f32 v148, v148
    v_mfma_f32_32x32x16_bf16 v[96:111], v[72:75], v[16:19], v[96:111]
    v_exp_f32 v149, v149
    v_exp_f32 v150, v150
    v_exp_f32 v151, v151
    v_exp_f32 v152, v152
    v_exp_f32 v153, v153
    s_add_u32 m0, s60, 14336
    s_nop 0
    global_load_lds_dwordx4 v236, s[52:53]
    s_add_u32 s52, s52, 40960
    s_addc_u32 s53, s53, 0
    v_smfmac_f32_32x32x32_bf16 v[208:223], v[80:83], v[144:151], v243
    v_exp_f32 v154, v154
    v_exp_f32 v155, v155
    v_exp_f32 v156, v156
    v_exp_f32 v157, v157
    v_mfma_f32_32x32x16_bf16 v[112:127], v[72:75], v[20:23], v[112:127]
    v_exp_f32 v158, v158
    v_exp_f32 v159, v159
    s_add_u32 m0, s60, 17408
    s_nop 0
    global_load_lds_dwordx4 v234, s[52:53]
    v_exp_f32 v96, v96
    v_exp_f32 v97, v97
    v_smfmac_f32_32x32x32_bf16 v[208:223], v[84:87], v[152:159], v243
    s_add_u32 m0, s60, 15360
    s_nop 0
    global_load_lds_dwordx4 v232, s[52:53]
    v_exp_f32 v98, v98
    v_exp_f32 v99, v99
    v_exp_f32 v100, v100
    v_mfma_f32_32x32x4_2b_bf16 v[128:159], v[76:77], v[34:35], 0 cbsz:1 abid:1
    v_exp_f32 v101, v101
    v_exp_f32 v102, v102
    v_exp_f32 v103, v103
    v_exp_f32 v104, v104
    v_exp_f32 v105, v105
    v_exp_f32 v106, v106
    v_exp_f32 v107, v107
    v_exp_f32 v108, v108
    s_add_u32 m0, s60, 16384
    s_nop 0
    global_load_lds_dwordx4 v233, s[52:53]
    v_smfmac_f32_32x32x32_bf16 v[160:175], v[88:91], v[96:103], v243
    v_exp_f32 v109, v109
    v_exp_f32 v110, v110
    v_exp_f32 v111, v111
    v_exp_f32 v112, v112
    v_exp_f32 v113, v113
    v_smfmac_f32_32x32x32_bf16 v[160:175], v[92:95], v[104:111], v243
    s_add_u32 m0, s60, 18432
    s_nop 0
    global_load_lds_dwordx4 v235, s[52:53]
    v_exp_f32 v114, v114
    v_exp_f32 v115, v115
    v_exp_f32 v116, v116
    v_mfma_f32_32x32x16_bf16 v[128:143], v[72:75], v[24:27], v[128:143]
    v_exp_f32 v117, v117
    v_exp_f32 v118, v118
    v_exp_f32 v119, v119
    v_exp_f32 v120, v120
    v_exp_f32 v121, v121
    s_add_u32 m0, s60, 19456
    s_nop 0
    global_load_lds_dwordx4 v236, s[52:53]
    s_add_u32 s52, s52, 40960
    s_addc_u32 s53, s53, 0
    v_smfmac_f32_32x32x32_bf16 v[176:191], v[88:91], v[112:119], v243
    v_exp_f32 v122, v122
    v_exp_f32 v123, v123
    v_exp_f32 v124, v124
    v_exp_f32 v125, v125
    v_mfma_f32_32x32x16_bf16 v[144:159], v[72:75], v[28:31], v[144:159]
    v_exp_f32 v126, v126
    v_exp_f32 v127, v127
    s_add_u32 m0, s60, 22528
    s_nop 0
    global_load_lds_dwordx4 v234, s[52:53]
    v_exp_f32 v128, v128
    v_exp_f32 v129, v129
    v_smfmac_f32_32x32x32_bf16 v[176:191], v[92:95], v[120:127], v243
    ds_write_b128 v248, v[160:163] offset:0
    ds_write_b128 v248, v[164:167] offset:1024
    ds_write_b128 v248, v[168:171] offset:2048
    ds_write_b32 v252, v168
    s_add_u32 m0, s60, 20480
    s_nop 0
    global_load_lds_dwordx4 v232, s[52:53]
    v_exp_f32 v130, v130
    v_exp_f32 v131, v131
    v_exp_f32 v132, v132
    v_exp_f32 v133, v133
    v_exp_f32 v134, v134
    v_exp_f32 v135, v135
    v_exp_f32 v136, v136
    v_exp_f32 v137, v137
    v_exp_f32 v138, v138
    v_exp_f32 v139, v139
    v_exp_f32 v140, v140
    s_add_u32 m0, s60, 21504
    s_nop 0
    global_load_lds_dwordx4 v233, s[52:53]
    v_smfmac_f32_32x32x32_bf16 v[192:207], v[88:91], v[128:135], v243
    v_exp_f32 v141, v141
    v_exp_f32 v142, v142
    v_exp_f32 v143, v143
    v_exp_f32 v144, v144
    v_exp_f32 v145, v145
    v_smfmac_f32_32x32x32_bf16 v[192:207], v[92:95], v[136:143], v243
    ds_write_b128 v249, v[176:179] offset:3072
    ds_write_b128 v249, v[180:183] offset:4096
    ds_write_b128 v249, v[184:187] offset:5120
    ds_write_b32 v253, v184
    s_add_u32 m0, s60, 23552
    s_nop 0
    global_load_lds_dwordx4 v235, s[52:53]
    v_exp_f32 v146, v146
    v_exp_f32 v147, v147
    v_exp_f32 v148, v148
    v_exp_f32 v149, v149
    v_exp_f32 v150, v150
    v_exp_f32 v151, v151
    v_exp_f32 v152, v152
    v_exp_f32 v153, v153
    s_add_u32 m0, s60, 24576
    s_nop 0
    global_load_lds_dwordx4 v236, s[52:53]
    s_add_u32 s52, s52, 40960
    s_addc_u32 s53, s53, 0
    v_smfmac_f32_32x32x32_bf16 v[208:223], v[88:91], v[144:151], v243
    v_exp_f32 v154, v154
    v_exp_f32 v155, v155
    v_exp_f32 v156, v156
    v_exp_f32 v157, v157
    v_exp_f32 v158, v158
    v_exp_f32 v159, v159
    s_branch L_lastE
L_lastB:
    v_exp_f32 v128, v128
    v_exp_f32 v129, v129
    v_smfmac_f32_32x32x32_bf16 v[176:191], v[64:67], v[120:127], v243
    v_exp_f32 v130, v130
    v_exp_f32 v131, v131
    v_exp_f32 v132, v132
    v_mfma_f32_32x32x4_2b_bf16 v[96:127], v[76:77], v[32:33], 0 cbsz:1 abid:0
    v_exp_f32 v133, v133
    v_exp_f32 v134, v134
    v_exp_f32 v135, v135
    v_exp_f32 v136, v136
    v_exp_f32 v137, v137
    v_exp_f32 v138, v138
    v_exp_f32 v139, v139
    v_exp_f32 v140, v140
    v_smfmac_f32_32x32x32_bf16 v[192:207], v[60:63], v[128:135], v243
    v_exp_f32 v141, v141
    v_exp_f32 v142, v142
    v_exp_f32 v143, v143
    v_exp_f32 v144, v144
    v_exp_f32 v145, v145
    v_smfmac_f32_32x32x32_bf16 v[192:207], v[64:67], v[136:143], v243
    v_exp_f32 v146, v146
    v_exp_f32 v147, v147
    v_exp_f32 v148, v148
    v_mfma_f32_32x32x16_bf16 v[96:111], v[68:71], v[16:19], v[96:111]
    v_exp_f32 v149, v149
    v_exp_f32 v150, v150
    v_exp_f32 v151, v151
    v_exp_f32 v152, v152
    v_exp_f32 v153, v153
    v_smfmac_f32_32x32x32_bf16 v[208:223], v[60:63], v[144:151], v243
    v_exp_f32 v154, v154
    v_exp_f32 v155, v155
    v_exp_f32 v156, v156
    v_exp_f32 v157, v157
    v_mfma_f32_32x32x16_bf16 v[112:127], v[68:71], v[20:23], v[112:127]
    v_exp_f32 v158, v158
    v_exp_f32 v159, v159
    v_exp_f32 v96, v96
    v_exp_f32 v97, v97
    v_smfmac_f32_32x32x32_bf16 v[208:223], v[64:67], v[152:159], v243
    v_exp_f32 v98, v98
    v_exp_f32 v99, v99
    v_exp_f32 v100, v100
    v_mfma_f32_32x32x4_2b_bf16 v[128:159], v[76:77], v[34:35], 0 cbsz:1 abid:0
    v_exp_f32 v101, v101
    v_exp_f32 v102, v102
    v_exp_f32 v103, v103
    v_exp_f32 v104, v104
    v_exp_f32 v105, v105
    v_exp_f32 v106, v106
    v_exp_f32 v107, v107
    v_exp_f32 v108, v108
    v_smfmac_f32_32x32x32_bf16 v[160:175], v[80:83], v[96:103], v243
    v_exp_f32 v109, v109
    v_exp_f32 v110, v110
    v_exp_f32 v111, v111
    v_exp_f32 v112, v112
    v_exp_f32 v113, v113
    v_smfmac_f32_32x32x32_bf16 v[160:175], v[84:87], v[104:111], v243
    v_exp_f32 v114, v114
    v_exp_f32 v115, v115
    v_exp_f32 v116, v116
    v_mfma_f32_32x32x16_bf16 v[128:143], v[68:71], v[24:27], v[128:143]
    v_exp_f32 v117, v117
    v_exp_f32 v118, v118
    v_exp_f32 v119, v119
    v_exp_f32 v120, v120
    v_exp_f32 v121, v121
    v_smfmac_f32_32x32x32_bf16 v[176:191], v[80:83], v[112:119], v243
    v_exp_f32 v122, v122
    v_exp_f32 v123, v123
    v_exp_f32 v124, v124
    v_exp_f32 v125, v125
    v_mfma_f32_32x32x16_bf16 v[144:159], v[68:71], v[28:31], v[144:159]
    v_exp_f32 v126, v126
    v_exp_f32 v127, v127
    v_exp_f32 v128, v128
    v_exp_f32 v129, v129
    v_smfmac_f32_32x32x32_bf16 v[176:191], v[84:87], v[120:127], v243
    v_exp_f32 v130, v130
    v_exp_f32 v131, v131
    v_exp_f32 v132, v132
    v_mfma_f32_32x32x4_2b_bf16 v[96:127], v[76:77], v[32:33], 0 cbsz:1 abid:1
    v_exp_f32 v133, v133
    v_exp_f32 v134, v134
    v_exp_f32 v135, v135
    v_exp_f32 v136, v136
    v_exp_f32 v137, v137
    v_exp_f32 v138, v138
    v_exp_f32 v139, v139
    v_exp_f32 v140, v140
    v_smfmac_f32_32x32x32_bf16 v[192:207], v[80:83], v[128:135], v243
    v_exp_f32 v141, v141
    v_exp_f32 v142, v142
    v_exp_f32 v143, v143
    v_exp_f32 v144, v144
    v_exp_f32 v145, v145
    v_smfmac_f32_32x32x32_bf16 v[192:207], v[84:87], v[136:143], v243
    v_exp_f32 v146, v146
    v_exp_f32 v147, v147
    v_exp_f32 v148, v148
    v_mfma_f32_32x32x16_bf16 v[96:111], v[72:75], v[16:19], v[96:111]
    v_exp_f32 v149, v149
    v_exp_f32 v150, v150
    v_exp_f32 v151, v151
    v_exp_f32 v152, v152
    v_exp_f32 v153, v153
    v_smfmac_f32_32x32x32_bf16 v[208:223], v[80:83], v[144:151], v243
    v_exp_f32 v154, v154
    v_exp_f32 v155, v155
    v_exp_f32 v156, v156
    v_exp_f32 v157, v157
    v_mfma_f32_32x32x16_bf16 v[112:127], v[72:75], v[20:23], v[112:127]
    v_exp_f32 v158, v158
    v_exp_f32 v159, v159
    v_exp_f32 v96, v96
    v_exp_f32 v97, v97
    v_smfmac_f32_32x32x32_bf16 v[208:223], v[84:87], v[152:159], v243
    v_exp_f32 v98, v98
    v_exp_f32 v99, v99
    v_exp_f32 v100, v100
    v_mfma_f32_32x32x4_2b_bf16 v[128:159], v[76:77], v[34:35], 0 cbsz:1 abid:1
    v_exp_f32 v101, v101
    v_exp_f32 v102, v102
    v_exp_f32 v103, v103
    v_exp_f32 v104, v104
    v_exp_f32 v105, v105
    v_exp_f32 v106, v106
    v_exp_f32 v107, v107
    v_exp_f32 v108, v108
    v_smfmac_f32_32x32x32_bf16 v[160:175], v[88:91], v[96:103], v243
    v_exp_f32 v109, v109
    v_exp_f32 v110, v110
    v_exp_f32 v111, v111
    v_exp_f32 v112, v112
    v_exp_f32 v113, v113
    v_smfmac_f32_32x32x32_bf16 v[160:175], v[92:95], v[104:111], v243
    v_exp_f32 v114, v114
    v_exp_f32 v115, v115
    v_exp_f32 v116, v116
    v_mfma_f32_32x32x16_bf16 v[128:143], v[72:75], v[24:27], v[128:143]
    v_exp_f32 v117, v117
    v_exp_f32 v118, v118
    v_exp_f32 v119, v119
    v_exp_f32 v120, v120
    v_exp_f32 v121, v121
    v_smfmac_f32_32x32x32_bf16 v[176:191], v[88:91], v[112:119], v243
    v_exp_f32 v122, v122
    v_exp_f32 v123, v123
    v_exp_f32 v124, v124
    v_exp_f32 v125, v125
    v_mfma_f32_32x32x16_bf16 v[144:159], v[72:75], v[28:31], v[144:159]
    v_exp_f32 v126, v126
    v_exp_f32 v127, v127
    v_exp_f32 v128, v128
    v_exp_f32 v129, v129
    v_smfmac_f32_32x32x32_bf16 v[176:191], v[92:95], v[120:127], v243
    ds_write_b128 v248, v[160:163] offset:0
    ds_write_b128 v248, v[164:167] offset:1024
    ds_write_b128 v248, v[168:171] offset:2048
    ds_write_b32 v252, v168
    v_exp_f32 v130, v130
    v_exp_f32 v131, v131
    v_exp_f32 v132, v132
    v_exp_f32 v133, v133
    v_exp_f32 v134, v134
    v_exp_f32 v135, v135
    v_exp_f32 v136, v136
    v_exp_f32 v137, v137
    v_exp_f32 v138, v138
    v_exp_f32 v139, v139
    v_exp_f32 v140, v140
    v_smfmac_f32_32x32x32_bf16 v[192:207], v[88:91], v[128:135], v243
    v_exp_f32 v141, v141
    v_exp_f32 v142, v142
    v_exp_f32 v143, v143
    v_exp_f32 v144, v144
    v_exp_f32 v145, v145
    v_smfmac_f32_32x32x32_bf16 v[192:207], v[92:95], v[136:143], v243
    ds_write_b128 v249, v[176:179] offset:3072
    ds_write_b128 v249, v[180:183] offset:4096
    ds_write_b128 v249, v[184:187] offset:5120
    ds_write_b32 v253, v184
    ds_write_b32 v9, v227
    v_exp_f32 v146, v146
    v_exp_f32 v147, v147
    v_exp_f32 v148, v148
    v_exp_f32 v149, v149
    v_exp_f32 v150, v150
    v_exp_f32 v151, v151
    v_exp_f32 v152, v152
    v_exp_f32 v153, v153
    s_wakeup
    v_smfmac_f32_32x32x32_bf16 v[208:223], v[88:91], v[144:151], v243
    v_exp_f32 v154, v154
    v_exp_f32 v155, v155
    v_exp_f32 v156, v156
    v_exp_f32 v157, v157
    v_exp_f32 v158, v158
    v_exp_f32 v159, v159
L_lastE:
    s_nop 1
    v_smfmac_f32_32x32x32_bf16 v[208:223], v[92:95], v[152:159], v243
L_send:
    ds_write_b128 v250, v[192:195] offset:6144
    ds_write_b128 v250, v[196:199] offset:7168
    ds_write_b128 v250, v[200:203] offset:8192
    ds_write_b32 v254, v200
    s_nop 7
    ds_write_b32 v255, v216
    s_mov_b64 exec, 1
    ds_add_u32 v226, v227
    s_mov_b64 exec, -1
    s_mov_b32 s47, 1048576
L_lw_33:
    ds_read_b32 v225, v226
    s_waitcnt lgkmcnt(0)
    v_readfirstlane_b32 s63, v225
    s_nop 0
    s_cmp_ge_u32 s63, s45
    s_cbranch_scc1 L_lwr_34
    s_sub_u32 s47, s47, 1
    s_cbranch_scc0 L_lw_33
L_lwr_34:
    ds_read_b128 v[140:143], v244
    ds_read_b128 v[132:135], v247
    ds_read_b128 v[136:139], v247 offset:1024
    ds_read_b128 v[96:99], v251 offset:0
    ds_read_b128 v[108:111], v251 offset:3072
    ds_read_b128 v[120:123], v251 offset:6144
    ds_read_b128 v[100:103], v251 offset:1024
    ds_read_b128 v[112:115], v251 offset:4096
    ds_read_b128 v[124:127], v251 offset:7168
    ds_read_b128 v[104:107], v251 offset:2048
    ds_read_b128 v[116:119], v251 offset:5120
    ds_read_b128 v[128:131], v251 offset:8192
L_lwe_35:
    s_waitcnt lgkmcnt(9)
    v_add_f32 v140, v140, v142
    v_add_f32 v141, v141, v143
    v_add_f32 v140, v140, v141
    v_add_f32 v132, v132, v134
    v_add_f32 v133, v133, v135
    v_add_f32 v132, v132, v133
    v_add_f32 v136, v136, v138
    v_add_f32 v137, v137, v139
    v_add_f32 v136, v136, v137
    v_rcp_f32 v142, v140
    v_subrev_u32 v132, 0x21800000, v132
    v_subrev_u32 v136, 0x21800000, v136
    v_max_u32 v132, v132, v136
    v_cmp_lt_u32 vcc, 0x3c000000, v132
    s_nop 0
    s_cbranch_vccz L_fin
    s_cmp_eq_u32 s44, 0
    s_cbranch_scc1 L_slow
L_fin:
    s_cmp_eq_u32 s40, 0
    s_cbranch_scc1 L_finA
    s_waitcnt lgkmcnt(6)
    v_add_f32 v208, v208, v96
    v_add_f32 v209, v209, v97
    v_add_f32 v108, v108, v120
    v_add_f32 v109, v109, v121
    v_add_f32 v208, v208, v108
    v_add_f32 v209, v209, v109
    v_mul_f32 v208, v208, v142
    v_mul_f32 v209, v209, v142
    v_cvt_pk_bf16_f32 v144, v208, v209
    v_min_u32 v144, -2, v144
    v_add_f32 v210, v210, v98
    v_add_f32 v211, v211, v99
    v_add_f32 v110, v110, v122
    v_add_f32 v111, v111, v123
    v_add_f32 v210, v210, v110
    v_add_f32 v211, v211, v111
    v_mul_f32 v210, v210, v142
    v_mul_f32 v211, v211, v142
    v_cvt_pk_bf16_f32 v145, v210, v211
    s_waitcnt lgkmcnt(3)
    v_add_f32 v212, v212, v100
    v_add_f32 v213, v213, v101
    v_add_f32 v112, v112, v124
    v_add_f32 v113, v113, v125
    v_add_f32 v212, v212, v112
    v_add_f32 v213, v213, v113
    v_mul_f32 v212, v212, v142
    v_mul_f32 v213, v213, v142
    v_cvt_pk_bf16_f32 v146, v212, v213
    v_min_u32 v146, -2, v146
    v_add_f32 v214, v214, v102
    v_add_f32 v215, v215, v103
    v_add_f32 v114, v114, v126
    v_add_f32 v115, v115, v127
    v_add_f32 v214, v214, v114
    v_add_f32 v215, v215, v115
    v_mul_f32 v214, v214, v142
    v_mul_f32 v215, v215, v142
    v_cvt_pk_bf16_f32 v147, v214, v215
    s_waitcnt lgkmcnt(0)
    v_add_f32 v216, v216, v104
    v_add_f32 v217, v217, v105
    v_add_f32 v116, v116, v128
    v_add_f32 v117, v117, v129
    v_add_f32 v216, v216, v116
    v_add_f32 v217, v217, v117
    v_mul_f32 v216, v216, v142
    v_mul_f32 v217, v217, v142
    v_cvt_pk_bf16_f32 v148, v216, v217
    v_min_u32 v148, -2, v148
    v_permlane32_swap_b32 v144, v146
    v_permlane32_swap_b32 v145, v147
    v_add_f32 v218, v218, v106
    v_add_f32 v219, v219, v107
    v_add_f32 v118, v118, v130
    v_add_f32 v119, v119, v131
    v_add_f32 v218, v218, v118
    v_add_f32 v219, v219, v119
    v_mul_f32 v218, v218, v142
    v_mul_f32 v219, v219, v142
    v_cvt_pk_bf16_f32 v149, v218, v219
    s_branch L_finB
L_finA:
    s_waitcnt lgkmcnt(6)
    v_pk_add_f32 v[208:209], v[208:209], v[96:97]
    v_pk_add_f32 v[108:109], v[108:109], v[120:121]
    v_pk_add_f32 v[208:209], v[208:209], v[108:109]
    v_pk_mul_f32 v[208:209], v[208:209], v[142:143] op_sel_hi:[1,0]
    v_cvt_pk_bf16_f32 v144, v208, v209
    v_min_u32 v144, -2, v144
    v_pk_add_f32 v[210:211], v[210:211], v[98:99]
    v_pk_add_f32 v[110:111], v[110:111], v[122:123]
    v_pk_add_f32 v[210:211], v[210:211], v[110:111]
    v_pk_mul_f32 v[210:211], v[210:211], v[142:143] op_sel_hi:[1,0]
    v_cvt_pk_bf16_f32 v145, v210, v211
    s_waitcnt lgkmcnt(3)
    v_pk_add_f32 v[212:213], v[212:213], v[100:101]
    v_pk_add_f32 v[112:113], v[112:113], v[124:125]
    v_pk_add_f32 v[212:213], v[212:213], v[112:113]
    v_pk_mul_f32 v[212:213], v[212:213], v[142:143] op_sel_hi:[1,0]
    v_cvt_pk_bf16_f32 v146, v212, v213
    v_min_u32 v146, -2, v146
    v_pk_add_f32 v[214:215], v[214:215], v[102:103]
    v_pk_add_f32 v[114:115], v[114:115], v[126:127]
    v_pk_add_f32 v[214:215], v[214:215], v[114:115]
    v_pk_mul_f32 v[214:215], v[214:215], v[142:143] op_sel_hi:[1,0]
    v_cvt_pk_bf16_f32 v147, v214, v215
    s_waitcnt lgkmcnt(0)
    v_pk_add_f32 v[216:217], v[216:217], v[104:105]
    v_pk_add_f32 v[116:117], v[116:117], v[128:129]
    v_pk_add_f32 v[216:217], v[216:217], v[116:117]
    v_pk_mul_f32 v[216:217], v[216:217], v[142:143] op_sel_hi:[1,0]
    v_cvt_pk_bf16_f32 v148, v216, v217
    v_min_u32 v148, -2, v148
    v_permlane32_swap_b32 v144, v146
    v_permlane32_swap_b32 v145, v147
    v_pk_add_f32 v[218:219], v[218:219], v[106:107]
    v_pk_add_f32 v[118:119], v[118:119], v[130:131]
    v_pk_add_f32 v[218:219], v[218:219], v[118:119]
    v_pk_mul_f32 v[218:219], v[218:219], v[142:143] op_sel_hi:[1,0]
    v_cvt_pk_bf16_f32 v149, v218, v219
L_finB:
    s_and_b32 s58, s91, s40
    s_bitcmp1_b32 s39, 0
    s_cbranch_scc1 L_finodd
    s_cmp_eq_u32 s58, 0
    s_cbranch_scc1 L_psg_36
    global_store_dwordx4 v245, v[144:147], s[36:37]
    s_mov_b64 exec, s[76:77]
    global_store_dwordx2 v246, v[148:149], s[36:37] offset:512
    s_branch L_pse_37
L_psg_36:
    global_store_dwordx4 v245, v[144:147], s[36:37] sc1
    s_mov_b64 exec, s[76:77]
    global_store_dwordx2 v246, v[148:149], s[36:37] offset:512 sc1
L_pse_37:
    s_branch L_fine
L_finodd:
    v_permlane32_swap_b32 v144, v148
    v_permlane32_swap_b32 v145, v149
    v_cndmask_b32 v148, v144, v148, s[76:77]
    v_cndmask_b32 v149, v145, v149, s[76:77]
    s_cmp_eq_u32 s58, 0
    s_cbranch_scc1 L_psg_38
    global_store_dwordx4 v245, v[146:149], s[36:37]
    s_mov_b64 exec, s[76:77]
    global_store_dwordx2 v246, v[144:145], s[36:37] offset:512
    s_branch L_pse_39
L_psg_38:
    global_store_dwordx4 v245, v[146:149], s[36:37] sc1
    s_mov_b64 exec, s[76:77]
    global_store_dwordx2 v246, v[144:145], s[36:37] offset:512 sc1
L_pse_39:
L_fine:
    s_mov_b64 exec, -1
    s_cmp_lg_u32 s40, 0
    s_cbranch_scc1 L_ffn
    s_cmp_lt_u32 s97, 176
    s_cbranch_scc1 L_nom2
    s_add_u32 s45, s45, 4
    v_mov_b32 v88, s72
    v_mov_b32 v89, 1
    s_mov_b64 exec, 1
    ds_add_u32 v88, v89
    s_mov_b64 exec, -1
    s_sub_u32 s93, s97, 136
    s_lshl_b32 s93, s93, 1
    s_mul_i32 s58, s39, 1228800
    s_lshl_b32 s59, s93, 5
    s_add_u32 s58, s58, s59
    s_add_u32 s52, s30, s58
    s_addc_u32 s53, s31, 0
    v_lshrrev_b32 v90, 2, v1
    v_mul_u32_u24 v90, 7680, v90
    v_and_b32 v84, 3, v1
    v_lshl_add_u32 v90, v84, 4, v90
    s_mul_i32 s60, s39, 10240
    s_add_u32 s60, s60, 102400
    v_lshlrev_b32 v85, 3, v84
    v_lshrrev_b32 v84, 2, v2
    v_lshl_add_u32 v85, v84, 6, v85
    v_lshl_add_u32 v85, v3, 9, v85
    v_add_u32 v85, s60, v85
    s_mul_i32 s58, s39, 320
    s_add_u32 s58, s58, 157696
    v_lshl_add_u32 v84, v3, 4, s58
    v_and_b32 v94, 2, v2
    v_lshlrev_b32 v94, 5, v94
    v_lshl_add_u32 v94, v3, 4, v94
    s_sub_u32 s58, s97, 176
    s_mul_i32 s59, s58, 3277
    s_lshr_b32 s59, s59, 16
    s_mul_i32 s59, s59, 20
    s_sub_u32 s59, s58, s59
    s_lshl_b32 s59, s59, 6
    v_lshrrev_b32 v95, 1, v94
    v_add_u32 v95, s59, v95
    global_load_dwordx2 v[92:93], v95, s[20:21]
    s_lshl_b32 s58, s58, 7
    s_add_u32 s58, s58, 4063232
    v_add_u32 v94, s58, v94
    s_mov_b32 s47, 1048576
L_lw_40:
    ds_read_b32 v89, v88
    s_waitcnt lgkmcnt(0)
    v_readfirstlane_b32 s63, v89
    s_nop 0
    s_cmp_ge_u32 s63, s45
    s_cbranch_scc1 L_lwr_41
    s_sleep 3
    s_sub_u32 s47, s47, 1
    s_cbranch_scc0 L_lw_40
L_lwr_41:
L_lwe_42:
    s_add_u32 m0, s60, 0
    s_waitcnt vmcnt(30)
    global_load_lds_dwordx4 v90, s[52:53]
    s_add_u32 s52, s52, 122880
    s_addc_u32 s53, s53, 0
    s_add_u32 m0, s60, 1024
    s_waitcnt vmcnt(30)
    global_load_lds_dwordx4 v90, s[52:53]
    s_add_u32 s52, s52, 122880
    s_addc_u32 s53, s53, 0
    s_add_u32 m0, s60, 2048
    s_waitcnt vmcnt(30)
    global_load_lds_dwordx4 v90, s[52:53]
    s_add_u32 s52, s52, 122880
    s_addc_u32 s53, s53, 0
    s_add_u32 m0, s60, 3072
    s_waitcnt vmcnt(30)
    global_load_lds_dwordx4 v90, s[52:53]
    s_add_u32 s52, s52, 122880
    s_addc_u32 s53, s53, 0
    s_add_u32 m0, s60, 4096
    s_waitcnt vmcnt(30)
    global_load_lds_dwordx4 v90, s[52:53]
    s_add_u32 s52, s52, 122880
    s_addc_u32 s53, s53, 0
    s_add_u32 m0, s60, 5120
    s_waitcnt vmcnt(30)
    global_load_lds_dwordx4 v90, s[52:53]
    s_add_u32 s52, s52, 122880
    s_addc_u32 s53, s53, 0
    s_add_u32 m0, s60, 6144
    s_waitcnt vmcnt(30)
    global_load_lds_dwordx4 v90, s[52:53]
    s_add_u32 s52, s52, 122880
    s_addc_u32 s53, s53, 0
    s_add_u32 m0, s60, 7168
    s_waitcnt vmcnt(30)
    global_load_lds_dwordx4 v90, s[52:53]
    s_add_u32 s52, s52, 122880
    s_addc_u32 s53, s53, 0
    s_add_u32 m0, s60, 8192
    s_waitcnt vmcnt(30)
    global_load_lds_dwordx4 v90, s[52:53]
    s_add_u32 s52, s52, 122880
    s_addc_u32 s53, s53, 0
    s_add_u32 m0, s60, 9216
    s_waitcnt vmcnt(30)
    global_load_lds_dwordx4 v90, s[52:53]
    ds_read_b128 v[16:19], v84 offset:0
    ds_read_b128 v[20:23], v84 offset:64
    ds_read_b128 v[24:27], v84 offset:128
    ds_read_b128 v[28:31], v84 offset:192
    ds_read_b128 v[32:35], v84 offset:256
    s_waitcnt vmcnt(0)
    s_mov_b64 exec, 1
    s_cmp_eq_u32 s91, 0
    s_cbranch_scc1 L_psg_43
    global_store_dword v237, v238, s[36:37]
    s_branch L_pse_44
L_psg_43:
    global_store_dword v237, v238, s[36:37] sc1
L_pse_44:
    s_mov_b64 exec, -1
    ds_read_b64_tr_b16 v[36:37], v85 offset:0
    ds_read_b64_tr_b16 v[38:39], v85 offset:256
    ds_read_b64_tr_b16 v[40:41], v85 offset:2048
    ds_read_b64_tr_b16 v[42:43], v85 offset:2304
    ds_read_b64_tr_b16 v[44:45], v85 offset:4096
    ds_read_b64_tr_b16 v[46:47], v85 offset:4352
    ds_read_b64_tr_b16 v[48:49], v85 offset:6144
    ds_read_b64_tr_b16 v[50:51], v85 offset:6400
    ds_read_b64_tr_b16 v[52:53], v85 offset:8192
    ds_read_b64_tr_b16 v[54:55], v85 offset:8448
    ds_read_b64_tr_b16 v[56:57], v85 offset:32
    ds_read_b64_tr_b16 v[58:59], v85 offset:288
    ds_read_b64_tr_b16 v[60:61], v85 offset:2080
    ds_read_b64_tr_b16 v[62:63], v85 offset:2336
    ds_read_b64_tr_b16 v[64:65], v85 offset:4128
    ds_read_b64_tr_b16 v[66:67], v85 offset:4384
    ds_read_b64_tr_b16 v[68:69], v85 offset:6176
    ds_read_b64_tr_b16 v[70:71], v85 offset:6432
    ds_read_b64_tr_b16 v[72:73], v85 offset:8224
    ds_read_b64_tr_b16 v[74:75], v85 offset:8480
    s_waitcnt lgkmcnt(0)
    v_mfma_f32_16x16x32_bf16 v[76:79], v[36:39], v[16:19], 0
    v_mfma_f32_16x16x32_bf16 v[80:83], v[56:59], v[16:19], 0
    v_mfma_f32_16x16x32_bf16 v[76:79], v[40:43], v[20:23], v[76:79]
    v_mfma_f32_16x16x32_bf16 v[80:83], v[60:63], v[20:23], v[80:83]
    v_mfma_f32_16x16x32_bf16 v[76:79], v[44:47], v[24:27], v[76:79]
    v_mfma_f32_16x16x32_bf16 v[80:83], v[64:67], v[24:27], v[80:83]
    v_mfma_f32_16x16x32_bf16 v[76:79], v[48:51], v[28:31], v[76:79]
    v_mfma_f32_16x16x32_bf16 v[80:83], v[68:71], v[28:31], v[80:83]
    v_mfma_f32_16x16x32_bf16 v[76:79], v[52:55], v[32:35], v[76:79]
    v_mfma_f32_16x16x32_bf16 v[80:83], v[72:75], v[32:35], v[80:83]
    s_lshl_b32 s58, s39, 6
    s_add_u32 s58, s58, 158976
    v_lshl_add_u32 v86, v3, 4, s58
    v_and_b32 v84, 2, v2
    v_cmp_ne_u32 vcc, 0, v84
    v_lshl_add_u32 v86, v84, 7, v86
    s_nop 1
    v_cndmask_b32 v76, v76, v80, vcc
    v_cndmask_b32 v77, v77, v81, vcc
    v_cndmask_b32 v78, v78, v82, vcc
    v_cndmask_b32 v79, v79, v83, vcc
    s_cmp_eq_u32 s39, 0
    s_cbranch_scc1 L_mf_45
    ds_write_b128 v86, v[76:79]
    v_mov_b32 v84, 160296
    v_mov_b32 v85, 1
    s_mov_b64 exec, 1
    ds_add_u32 v84, v85
    s_mov_b64 exec, -1
    s_branch L_nom2
L_mf_45:
    v_mov_b32 v84, 160296
    s_lshl_b32 s58, s93, 7
    s_add_u32 s58, s58, 4096
    v_lshl_add_u32 v87, v3, 4, s58
    v_lshl_add_u32 v87, v2, 6, v87
    v_mov_b32 v29, s43
    v_mov_b32 v31, s43
    s_mov_b32 s47, 1048576
L_lw_46:
    ds_read_b32 v85, v84
    s_waitcnt lgkmcnt(0)
    v_readfirstlane_b32 s63, v85
    s_nop 0
    s_cmp_ge_u32 s63, 3
    s_cbranch_scc1 L_lwr_47
    s_sleep 3
    s_sub_u32 s47, s47, 1
    s_cbranch_scc0 L_lw_46
L_lwr_47:
    ds_read_b128 v[16:19], v86 offset:64
    ds_read_b128 v[20:23], v86 offset:128
    ds_read_b128 v[24:27], v86 offset:192
L_lwe_48:
    s_mov_b32 s52, 0x000f000f
    s_mov_b32 s53, 0x000f000f
    s_sub_u32 s58, s93, 160
    s_cmp_lt_u32 s58, 40
    s_waitcnt lgkmcnt(0)
    v_add_f32 v76, v76, v16
    v_add_f32 v77, v77, v17
    v_add_f32 v78, v78, v18
    v_add_f32 v79, v79, v19
    v_add_f32 v20, v20, v24
    v_add_f32 v21, v21, v25
    v_add_f32 v22, v22, v26
    v_add_f32 v23, v23, v27
    v_add_f32 v76, v76, v20
    v_add_f32 v77, v77, v21
    v_add_f32 v78, v78, v22
    v_add_f32 v79, v79, v23
    v_cvt_pk_bf16_f32 v28, v76, v77
    v_cvt_pk_bf16_f32 v30, v78, v79
    s_cbranch_scc0 L_mf_45_s
    v_lshlrev_b32 v76, 16, v28
    v_and_b32 v77, 0xffff0000, v28
    v_lshlrev_b32 v78, 16, v30
    v_and_b32 v79, 0xffff0000, v30
    v_add_f32 v76, 1.0, v76
    v_add_f32 v77, 1.0, v77
    v_add_f32 v78, 1.0, v78
    v_add_f32 v79, 1.0, v79
    v_cvt_pk_bf16_f32 v28, v76, v77
    v_cvt_pk_bf16_f32 v30, v78, v79
L_mf_45_s:
    v_lshlrev_b32 v76, 16, v28
    v_and_b32 v77, 0xffff0000, v28
    v_lshlrev_b32 v78, 16, v30
    v_and_b32 v79, 0xffff0000, v30
    v_lshlrev_b32 v16, 16, v92
    v_and_b32 v17, 0xffff0000, v92
    v_lshlrev_b32 v18, 16, v93
    v_and_b32 v19, 0xffff0000, v93
    v_mul_f32 v16, v16, v76
    v_mul_f32 v17, v17, v77
    v_mul_f32 v18, v18, v78
    v_mul_f32 v19, v19, v79
    v_and_b32 v84, 1, v2
    v_cmp_ne_u32 vcc, 0, v84
    v_add_f32 v20, v16, v17
    v_add_f32 v21, v18, v19
    v_lshl_add_u32 v84, v84, 14, v94
    v_add_f32 v20, v20, v21
    v_cndmask_b32 v76, v76, v16, vcc
    v_cndmask_b32 v77, v77, v17, vcc
    v_cndmask_b32 v78, v78, v18, vcc
    v_cndmask_b32 v79, v79, v19, vcc
    s_mov_b64 exec, s[52:53]
    global_store_dwordx4 v84, v[76:79], s[36:37] sc1
    s_mov_b64 exec, -1
    v_add_f32_dpp v20, v20, v20 quad_perm:[2,3,0,1] row_mask:0xf bank_mask:0xf
    s_lshl_b32 s58, s93, 1
    s_add_u32 s58, s58, 4095840
    v_mov_b32 v85, s58
    v_permlane32_swap_b32 v20, v21
    v_add_f32 v20, v20, v21
    s_nop 1
    v_permlane16_swap_b32 v20, v21
    v_add_f32 v20, v20, v21
    s_mov_b64 exec, 1
    global_store_dword v85, v20, s[36:37] sc1
    s_waitcnt vmcnt(0)
    s_mov_b64 exec, s[52:53]
    global_store_dwordx4 v87, v[28:31], s[36:37] sc1
    s_mov_b64 exec, -1
L_nom2:
    v_mov_b32 v68, 160256
    v_mov_b32 v69, 1
    s_mov_b64 exec, 1
    ds_add_u32 v68, v69 offset:12
    s_cmp_ge_u32 s97, 176
    s_cbranch_scc1 L_xfd
    s_waitcnt vmcnt(0)
    s_cmp_eq_u32 s91, 0
    s_cbranch_scc1 L_psg_49
    global_store_dword v237, v238, s[36:37]
    s_branch L_pse_50
L_psg_49:
    global_store_dword v237, v238, s[36:37] sc1
L_pse_50:
L_xfd:
    ds_add_u32 v68, v69 offset:16
    s_mov_b64 exec, -1
    s_mov_b32 s47, 1048576
L_lw_51:
    ds_read_b32 v70, v68 offset:16
    s_waitcnt lgkmcnt(0)
    v_readfirstlane_b32 s63, v70
    s_nop 0
    s_cmp_ge_u32 s63, 4
    s_cbranch_scc1 L_lwr_52
    s_sleep 2
    s_sub_u32 s47, s47, 1
    s_cbranch_scc0 L_lw_51
L_lwr_52:
L_lwe_53:
    ds_read_b64_tr_b16 v[116:117], v8 offset:0
    ds_read_b64_tr_b16 v[118:119], v8 offset:2560
    ds_read_b64_tr_b16 v[120:121], v8 offset:8
    ds_read_b64_tr_b16 v[122:123], v8 offset:2568
    ds_read_b64_tr_b16 v[124:125], v8 offset:16
    ds_read_b64_tr_b16 v[126:127], v8 offset:2576
    ds_read_b64_tr_b16 v[128:129], v8 offset:24
    ds_read_b64_tr_b16 v[130:131], v8 offset:2584
    ds_read_b64_tr_b16 v[132:133], v8 offset:32
    ds_read_b64_tr_b16 v[134:135], v8 offset:2592
    ds_read_b64_tr_b16 v[136:137], v8 offset:5120
    ds_read_b64_tr_b16 v[138:139], v8 offset:7680
    ds_read_b64_tr_b16 v[140:141], v8 offset:5128
    ds_read_b64_tr_b16 v[142:143], v8 offset:7688
    ds_read_b64_tr_b16 v[144:145], v8 offset:5136
    ds_read_b64_tr_b16 v[146:147], v8 offset:7696
    ds_read_b64_tr_b16 v[148:149], v8 offset:5144
    ds_read_b64_tr_b16 v[150:151], v8 offset:7704
    ds_read_b64_tr_b16 v[152:153], v8 offset:5152
    ds_read_b64_tr_b16 v[154:155], v8 offset:7712
    ds_read_b64_tr_b16 v[156:157], v8 offset:10240
    ds_read_b64_tr_b16 v[158:159], v8 offset:12800
    ds_read_b64_tr_b16 v[160:161], v8 offset:10248
    ds_read_b64_tr_b16 v[162:163], v8 offset:12808
    ds_read_b64_tr_b16 v[164:165], v8 offset:10256
    ds_read_b64_tr_b16 v[166:167], v8 offset:12816
    ds_read_b64_tr_b16 v[168:169], v8 offset:10264
    ds_read_b64_tr_b16 v[170:171], v8 offset:12824
    ds_read_b64_tr_b16 v[172:173], v8 offset:10272
    ds_read_b64_tr_b16 v[174:175], v8 offset:12832
    ds_read_b64_tr_b16 v[176:177], v8 offset:15360
    ds_read_b64_tr_b16 v[178:179], v8 offset:17920
    ds_read_b64_tr_b16 v[180:181], v8 offset:15368
    ds_read_b64_tr_b16 v[182:183], v8 offset:17928
    ds_read_b64_tr_b16 v[184:185], v8 offset:15376
    ds_read_b64_tr_b16 v[186:187], v8 offset:17936
    ds_read_b64_tr_b16 v[188:189], v8 offset:15384
    ds_read_b64_tr_b16 v[190:191], v8 offset:17944
    ds_read_b64_tr_b16 v[192:193], v8 offset:15392
    ds_read_b64_tr_b16 v[194:195], v8 offset:17952
    ds_read_b64_tr_b16 v[196:197], v8 offset:20480
    ds_read_b64_tr_b16 v[198:199], v8 offset:23040
    ds_read_b64_tr_b16 v[200:201], v8 offset:20488
    ds_read_b64_tr_b16 v[202:203], v8 offset:23048
    ds_read_b64_tr_b16 v[204:205], v8 offset:20496
    ds_read_b64_tr_b16 v[206:207], v8 offset:23056
    ds_read_b64_tr_b16 v[208:209], v8 offset:20504
    ds_read_b64_tr_b16 v[210:211], v8 offset:23064
    ds_read_b64_tr_b16 v[212:213], v8 offset:20512
    ds_read_b64_tr_b16 v[214:215], v8 offset:23072
    ds_read_b64_tr_b16 v[216:217], v8 offset:25600
    ds_read_b64_tr_b16 v[218:219], v8 offset:28160
    ds_read_b64_tr_b16 v[220:221], v8 offset:25608
    ds_read_b64_tr_b16 v[222:223], v8 offset:28168
    ds_read_b64_tr_b16 v[224:225], v8 offset:25616
    ds_read_b64_tr_b16 v[226:227], v8 offset:28176
    ds_read_b64_tr_b16 v[228:229], v8 offset:25624
    ds_read_b64_tr_b16 v[230:231], v8 offset:28184
    ds_read_b64_tr_b16 v[232:233], v8 offset:25632
    ds_read_b64_tr_b16 v[234:235], v8 offset:28192
    ds_read_b64_tr_b16 v[236:237], v8 offset:30720
    ds_read_b64_tr_b16 v[238:239], v8 offset:33280
    ds_read_b64_tr_b16 v[240:241], v8 offset:30728
    ds_read_b64_tr_b16 v[242:243], v8 offset:33288
    ds_read_b64_tr_b16 v[244:245], v8 offset:30736
    ds_read_b64_tr_b16 v[246:247], v8 offset:33296
    ds_read_b64_tr_b16 v[248:249], v8 offset:30744
    ds_read_b64_tr_b16 v[250:251], v8 offset:33304
    ds_read_b64_tr_b16 v[252:253], v8 offset:30752
    ds_read_b64_tr_b16 v[254:255], v8 offset:33312
    s_mov_b64 exec, 1
    ds_add_u32 v68, v69 offset:44
    s_mov_b64 exec, -1
    s_cmp_lg_u32 s66, 0
    s_cbranch_scc1 L_nt0
    s_not_b64 exec, s[76:77]
    global_load_dword v71, v10, s[36:37] sc1
    s_mov_b64 exec, -1
L_nt0:
    ds_read_b64_tr_b16 v[76:77], v8 offset:35840
    ds_read_b64_tr_b16 v[78:79], v8 offset:38400
    ds_read_b64_tr_b16 v[80:81], v8 offset:35848
    ds_read_b64_tr_b16 v[82:83], v8 offset:38408
    ds_read_b64_tr_b16 v[84:85], v8 offset:35856
    ds_read_b64_tr_b16 v[86:87], v8 offset:38416
    ds_read_b64_tr_b16 v[88:89], v8 offset:35864
    ds_read_b64_tr_b16 v[90:91], v8 offset:38424
    ds_read_b64_tr_b16 v[92:93], v8 offset:35872
    ds_read_b64_tr_b16 v[94:95], v8 offset:38432
    ds_read_b64_tr_b16 v[96:97], v8 offset:40960
    ds_read_b64_tr_b16 v[98:99], v8 offset:43520
    ds_read_b64_tr_b16 v[100:101], v8 offset:40968
    ds_read_b64_tr_b16 v[102:103], v8 offset:43528
    ds_read_b64_tr_b16 v[104:105], v8 offset:40976
    ds_read_b64_tr_b16 v[106:107], v8 offset:43536
    ds_read_b64_tr_b16 v[108:109], v8 offset:40984
    ds_read_b64_tr_b16 v[110:111], v8 offset:43544
    ds_read_b64_tr_b16 v[112:113], v8 offset:40992
    ds_read_b64_tr_b16 v[114:115], v8 offset:43552
    v_lshrrev_b32 v58, 1, v1
    v_and_b32 v59, 16, v9
    v_mad_u32_u24 v58, v58, s64, v59
    s_mov_b32 m0, s65
    s_mov_b32 s47, 1048576
L_lw_54:
    ds_read_b32 v70, v68 offset:44
    s_waitcnt lgkmcnt(0)
    v_readfirstlane_b32 s63, v70
    s_nop 0
    s_cmp_ge_u32 s63, 4
    s_cbranch_scc1 L_lwr_55
    s_sleep 2
    s_sub_u32 s47, s47, 1
    s_cbranch_scc0 L_lw_54
L_lwr_55:
L_lwe_56:
    s_cmp_eq_u32 s66, 0
    s_cbranch_scc1 L_fdn
L_fdl:
    global_load_lds_dwordx4 v58, s[34:35]
    s_add_u32 s34, s34, s67
    s_addc_u32 s35, s35, 0
    s_add_u32 m0, m0, 1024
    s_sub_u32 s66, s66, 1
    s_cmp_lg_u32 s66, 0
    s_waitcnt vmcnt(1)
    s_cbranch_scc1 L_fdl
    s_not_b64 exec, s[76:77]
    global_load_dword v71, v10, s[36:37] sc1
    s_mov_b64 exec, -1
    s_waitcnt vmcnt(0)
    s_branch L_fdx
L_fdn:
    s_waitcnt vmcnt(0)
L_fdx:
    v_cmp_ne_u32 s[54:55], s43, v71
    s_nop 0
    s_cmp_eq_u32 s55, 0
    s_cbranch_scc1 L_xfok
    s_not_b64 exec, s[76:77]
    s_mov_b32 s47, 131072
L_pm_57:
    global_load_dword v71, v10, s[36:37] sc1
    s_waitcnt vmcnt(0)
    v_cmp_ne_u32 vcc, s43, v71
    s_nop 0
    s_cbranch_vccz L_pme_58
    s_mov_b64 exec, vcc
    s_sleep 6
    s_sub_u32 s47, s47, 1
    s_cbranch_scc0 L_pm_57
L_pme_58:
    s_mov_b64 exec, -1
L_xfok:
    s_mov_b64 exec, 0x3ff
    s_mul_i32 s59, s42, 1280
    s_add_u32 s59, s59, 36864
    v_lshl_add_u32 v34, v1, 7, s59
    global_load_dword v44, v34, s[98:99] sc1
    s_mov_b64 exec, -1
    global_load_dwordx4 v[44:47], v9, s[98:99] offset:3072 sc1
    global_load_dwordx4 v[16:19], v9, s[98:99] offset:-4096 sc1
    global_load_dwordx4 v[20:23], v9, s[98:99] offset:-3072 sc1
    global_load_dwordx4 v[24:27], v9, s[98:99] offset:-2048 sc1
    global_load_dwordx4 v[28:31], v9, s[98:99] offset:-1024 sc1
    global_load_dwordx4 v[32:35], v9, s[98:99] offset:0 sc1
    global_load_dwordx4 v[36:39], v9, s[98:99] offset:1024 sc1
    global_load_dwordx4 v[40:43], v9, s[98:99] offset:2048 sc1
    global_load_dwordx4 v[48:51], v9, s[100:101] offset:-4096 sc1
    global_load_dwordx4 v[52:55], v9, s[100:101] offset:-3072 sc1
    s_waitcnt vmcnt(0)
    s_mov_b64 exec, s[76:77]
    s_mov_b32 s47, 131072
L_pm_59:
    global_load_dword v71, v10, s[36:37] sc1
    s_waitcnt vmcnt(0)
    v_cmp_ne_u32 vcc, s43, v71
    s_nop 0
    s_cbranch_vccz L_pme_60
    s_mov_b64 exec, vcc
    s_sleep 12
    s_sub_u32 s47, s47, 1
    s_cbranch_scc0 L_pm_59
L_pme_60:
    s_mov_b64 exec, -1
    s_mul_i32 s58, s39, 2560
    s_mul_i32 s59, s42, 320
    s_add_u32 s58, s58, s59
    s_add_u32 s58, s58, 4063232
    s_add_u32 s52, s36, s58
    s_addc_u32 s53, s37, 0
    s_lshl_b32 s58, s70, 1
    s_or_b32 s58, s58, s71
    s_mul_i32 s58, s58, 320
    s_add_u32 m0, s58, 160512
    s_mov_b64 exec, 0xfffff
    global_load_lds_dwordx4 v9, s[52:53] sc1
    s_cmp_lg_u32 s39, 2
    s_cbranch_scc1 L_noav
    s_mov_b32 m0, 161792
    s_add_u32 s52, s52, 16384
    s_addc_u32 s53, s53, 0
    global_load_lds_dwordx4 v9, s[52:53] sc1
    s_mov_b32 m0, 162112
    s_add_u32 s52, s36, 4096160
    s_addc_u32 s53, s37, 0
    s_mov_b64 exec, 0x1f
    global_load_lds_dwordx4 v9, s[52:53] sc1
L_noav:
    s_mov_b64 exec, -1
    s_mov_b32 s47, 131072
    s_lshl_b32 s58, s39, 2
    s_add_u32 s58, s58, 160320
    v_mov_b32 v10, s58
    s_mov_b32 s47, 131072
L_gt_61:
    ds_read_b32 v70, v10
    s_waitcnt lgkmcnt(0)
    v_readfirstlane_b32 s63, v70
    s_nop 0
    s_cmp_ge_u32 s63, 1
    s_cbranch_scc1 L_gte_62
    s_sleep 6
    s_sub_u32 s47, s47, 1
    s_cbranch_scc0 L_gt_61
L_gte_62:
    s_setprio 0
    v_mfma_f32_16x16x32_bf16 v[56:59], v[76:79], v[44:47], 0
    v_mfma_f32_16x16x32_bf16 v[60:63], v[80:83], v[44:47], 0
    v_mfma_f32_16x16x32_bf16 v[64:67], v[84:87], v[44:47], 0
    v_mfma_f32_16x16x32_bf16 v[68:71], v[88:91], v[44:47], 0
    v_mfma_f32_16x16x32_bf16 v[72:75], v[92:95], v[44:47], 0
    v_mfma_f32_16x16x32_bf16 v[56:59], v[116:119], v[16:19], v[56:59]
    v_mfma_f32_16x16x32_bf16 v[60:63], v[120:123], v[16:19], v[60:63]
    v_mfma_f32_16x16x32_bf16 v[64:67], v[124:127], v[16:19], v[64:67]
    v_mfma_f32_16x16x32_bf16 v[68:71], v[128:131], v[16:19], v[68:71]
    v_mfma_f32_16x16x32_bf16 v[72:75], v[132:135], v[16:19], v[72:75]
    ds_read_b64_tr_b16 v[76:77], v8 offset:46080
    ds_read_b64_tr_b16 v[78:79], v8 offset:48640
    ds_read_b64_tr_b16 v[80:81], v8 offset:46088
    ds_read_b64_tr_b16 v[82:83], v8 offset:48648
    ds_read_b64_tr_b16 v[84:85], v8 offset:46096
    ds_read_b64_tr_b16 v[86:87], v8 offset:48656
    ds_read_b64_tr_b16 v[88:89], v8 offset:46104
    ds_read_b64_tr_b16 v[90:91], v8 offset:48664
    ds_read_b64_tr_b16 v[92:93], v8 offset:46112
    ds_read_b64_tr_b16 v[94:95], v8 offset:48672
    v_mfma_f32_16x16x32_bf16 v[56:59], v[136:139], v[20:23], v[56:59]
    v_mfma_f32_16x16x32_bf16 v[60:63], v[140:143], v[20:23], v[60:63]
    v_mfma_f32_16x16x32_bf16 v[64:67], v[144:147], v[20:23], v[64:67]
    v_mfma_f32_16x16x32_bf16 v[68:71], v[148:151], v[20:23], v[68:71]
    v_mfma_f32_16x16x32_bf16 v[72:75], v[152:155], v[20:23], v[72:75]
    v_mfma_f32_16x16x32_bf16 v[56:59], v[156:159], v[24:27], v[56:59]
    v_mfma_f32_16x16x32_bf16 v[60:63], v[160:163], v[24:27], v[60:63]
    v_mfma_f32_16x16x32_bf16 v[64:67], v[164:167], v[24:27], v[64:67]
    v_mfma_f32_16x16x32_bf16 v[68:71], v[168:171], v[24:27], v[68:71]
    v_mfma_f32_16x16x32_bf16 v[72:75], v[172:175], v[24:27], v[72:75]
    v_mfma_f32_16x16x32_bf16 v[56:59], v[176:179], v[28:31], v[56:59]
    v_mfma_f32_16x16x32_bf16 v[60:63], v[180:183], v[28:31], v[60:63]
    v_mfma_f32_16x16x32_bf16 v[64:67], v[184:187], v[28:31], v[64:67]
    v_mfma_f32_16x16x32_bf16 v[68:71], v[188:191], v[28:31], v[68:71]
    v_mfma_f32_16x16x32_bf16 v[72:75], v[192:195], v[28:31], v[72:75]
    v_mfma_f32_16x16x32_bf16 v[56:59], v[196:199], v[32:35], v[56:59]
    v_mfma_f32_16x16x32_bf16 v[60:63], v[200:203], v[32:35], v[60:63]
    v_mfma_f32_16x16x32_bf16 v[64:67], v[204:207], v[32:35], v[64:67]
    v_mfma_f32_16x16x32_bf16 v[68:71], v[208:211], v[32:35], v[68:71]
    v_mfma_f32_16x16x32_bf16 v[72:75], v[212:215], v[32:35], v[72:75]
    v_mfma_f32_16x16x32_bf16 v[56:59], v[216:219], v[36:39], v[56:59]
    v_mfma_f32_16x16x32_bf16 v[60:63], v[220:223], v[36:39], v[60:63]
    v_mfma_f32_16x16x32_bf16 v[64:67], v[224:227], v[36:39], v[64:67]
    v_mfma_f32_16x16x32_bf16 v[68:71], v[228:231], v[36:39], v[68:71]
    v_mfma_f32_16x16x32_bf16 v[72:75], v[232:235], v[36:39], v[72:75]
    v_mfma_f32_16x16x32_bf16 v[56:59], v[236:239], v[40:43], v[56:59]
    v_mfma_f32_16x16x32_bf16 v[60:63], v[240:243], v[40:43], v[60:63]
    v_mfma_f32_16x16x32_bf16 v[64:67], v[244:247], v[40:43], v[64:67]
    v_mfma_f32_16x16x32_bf16 v[68:71], v[248:251], v[40:43], v[68:71]
    v_mfma_f32_16x16x32_bf16 v[72:75], v[252:255], v[40:43], v[72:75]
    v_mfma_f32_16x16x32_bf16 v[56:59], v[96:99], v[48:51], v[56:59]
    v_mfma_f32_16x16x32_bf16 v[60:63], v[100:103], v[48:51], v[60:63]
    v_mfma_f32_16x16x32_bf16 v[64:67], v[104:107], v[48:51], v[64:67]
    v_mfma_f32_16x16x32_bf16 v[68:71], v[108:111], v[48:51], v[68:71]
    v_mfma_f32_16x16x32_bf16 v[72:75], v[112:115], v[48:51], v[72:75]
    s_waitcnt lgkmcnt(0)
    v_mfma_f32_16x16x32_bf16 v[56:59], v[76:79], v[52:55], v[56:59]
    v_mfma_f32_16x16x32_bf16 v[60:63], v[80:83], v[52:55], v[60:63]
    v_mfma_f32_16x16x32_bf16 v[64:67], v[84:87], v[52:55], v[64:67]
    v_mfma_f32_16x16x32_bf16 v[68:71], v[88:91], v[52:55], v[68:71]
    v_mfma_f32_16x16x32_bf16 v[72:75], v[92:95], v[52:55], v[72:75]
    s_xor_b32 s60, s39, 0
    s_mul_i32 s58, s60, 3072
    s_add_u32 s58, s58, 143360
    s_lshr_b32 s60, s60, 1
    s_mul_i32 s60, s60, 51200
    s_lshl_b32 s59, s70, 11
    s_add_u32 s59, s59, s60
    s_add_u32 s59, s59, 28672
    v_add_u32 v16, s58, v9
    v_add_u32 v17, s59, v9
    s_add_u32 s98, s98, 40960
    s_addc_u32 s99, s99, 0
    s_add_u32 s100, s100, 40960
    s_addc_u32 s101, s101, 0
    ds_write_b128 v16, v[56:59] offset:0
    ds_write_b128 v16, v[60:63] offset:1024
    ds_write_b128 v16, v[64:67] offset:2048
    ds_write_b128 v17, v[68:71] offset:0
    ds_write_b128 v17, v[72:75] offset:1024
    s_setprio 2
    s_waitcnt vmcnt(0) lgkmcnt(0)
    s_barrier
    global_load_dwordx4 v[52:55], v9, s[100:101] offset:-3072 sc1
    global_load_dwordx4 v[16:19], v9, s[98:99] offset:-4096 sc1
    global_load_dwordx4 v[20:23], v9, s[98:99] offset:-3072 sc1
    global_load_dwordx4 v[24:27], v9, s[98:99] offset:-2048 sc1
    global_load_dwordx4 v[28:31], v9, s[98:99] offset:-1024 sc1
    global_load_dwordx4 v[32:35], v9, s[98:99] offset:0 sc1
    global_load_dwordx4 v[36:39], v9, s[98:99] offset:1024 sc1
    global_load_dwordx4 v[40:43], v9, s[98:99] offset:2048 sc1
    global_load_dwordx4 v[48:51], v9, s[100:101] offset:-4096 sc1
    global_load_dwordx4 v[44:47], v9, s[98:99] offset:3072 sc1
    s_mov_b32 s47, 131072
    s_waitcnt vmcnt(9)
    v_max_u32 v10, v52, v54
    v_cmp_eq_u32 vcc, -1, v10
    s_nop 0
    s_cbranch_vccnz L_or1_9
L_ob1_9:
    v_mfma_f32_16x16x32_bf16 v[56:59], v[76:79], v[52:55], 0
    v_mfma_f32_16x16x32_bf16 v[60:63], v[80:83], v[52:55], 0
    v_mfma_f32_16x16x32_bf16 v[64:67], v[84:87], v[52:55], 0
    v_mfma_f32_16x16x32_bf16 v[68:71], v[88:91], v[52:55], 0
    s_waitcnt vmcnt(8)
    v_max_u32 v10, v16, v18
    v_cmp_eq_u32 vcc, -1, v10
    v_mfma_f32_16x16x32_bf16 v[72:75], v[92:95], v[52:55], 0
    s_cbranch_vccnz L_or1_0
L_ob1_0:
    v_mfma_f32_16x16x32_bf16 v[56:59], v[116:119], v[16:19], v[56:59]
    v_mfma_f32_16x16x32_bf16 v[60:63], v[120:123], v[16:19], v[60:63]
    v_mfma_f32_16x16x32_bf16 v[64:67], v[124:127], v[16:19], v[64:67]
    v_mfma_f32_16x16x32_bf16 v[68:71], v[128:131], v[16:19], v[68:71]
    s_waitcnt vmcnt(7)
    v_max_u32 v10, v20, v22
    v_cmp_eq_u32 vcc, -1, v10
    v_mfma_f32_16x16x32_bf16 v[72:75], v[132:135], v[16:19], v[72:75]
    ds_read_b64_tr_b16 v[76:77], v8 offset:35840
    ds_read_b64_tr_b16 v[78:79], v8 offset:38400
    ds_read_b64_tr_b16 v[80:81], v8 offset:35848
    ds_read_b64_tr_b16 v[82:83], v8 offset:38408
    ds_read_b64_tr_b16 v[84:85], v8 offset:35856
    ds_read_b64_tr_b16 v[86:87], v8 offset:38416
    ds_read_b64_tr_b16 v[88:89], v8 offset:35864
    ds_read_b64_tr_b16 v[90:91], v8 offset:38424
    ds_read_b64_tr_b16 v[92:93], v8 offset:35872
    ds_read_b64_tr_b16 v[94:95], v8 offset:38432
    s_cbranch_vccnz L_or1_1
L_ob1_1:
    v_mfma_f32_16x16x32_bf16 v[56:59], v[136:139], v[20:23], v[56:59]
    v_mfma_f32_16x16x32_bf16 v[60:63], v[140:143], v[20:23], v[60:63]
    v_mfma_f32_16x16x32_bf16 v[64:67], v[144:147], v[20:23], v[64:67]
    v_mfma_f32_16x16x32_bf16 v[68:71], v[148:151], v[20:23], v[68:71]
    s_waitcnt vmcnt(6)
    v_max_u32 v10, v24, v26
    v_cmp_eq_u32 vcc, -1, v10
    v_mfma_f32_16x16x32_bf16 v[72:75], v[152:155], v[20:23], v[72:75]
    v_lshlrev_b32 v116, 16, v4
    v_and_b32 v117, 0xffff0000, v4
    v_lshlrev_b32 v118, 16, v5
    v_and_b32 v119, 0xffff0000, v5
    s_cbranch_vccnz L_or1_2
L_ob1_2:
    v_mfma_f32_16x16x32_bf16 v[56:59], v[156:159], v[24:27], v[56:59]
    v_mfma_f32_16x16x32_bf16 v[60:63], v[160:163], v[24:27], v[60:63]
    v_mfma_f32_16x16x32_bf16 v[64:67], v[164:167], v[24:27], v[64:67]
    v_mfma_f32_16x16x32_bf16 v[68:71], v[168:171], v[24:27], v[68:71]
    s_waitcnt vmcnt(5)
    v_max_u32 v10, v28, v30
    v_cmp_eq_u32 vcc, -1, v10
    v_mfma_f32_16x16x32_bf16 v[72:75], v[172:175], v[24:27], v[72:75]
    v_lshlrev_b32 v120, 16, v6
    v_and_b32 v121, 0xffff0000, v6
    v_lshlrev_b32 v122, 16, v7
    v_and_b32 v123, 0xffff0000, v7
    s_cbranch_vccnz L_or1_3
L_ob1_3:
    v_mfma_f32_16x16x32_bf16 v[56:59], v[176:179], v[28:31], v[56:59]
    v_mfma_f32_16x16x32_bf16 v[60:63], v[180:183], v[28:31], v[60:63]
    v_mfma_f32_16x16x32_bf16 v[64:67], v[184:187], v[28:31], v[64:67]
    v_mfma_f32_16x16x32_bf16 v[68:71], v[188:191], v[28:31], v[68:71]
    s_waitcnt vmcnt(4)
    v_max_u32 v10, v32, v34
    v_cmp_eq_u32 vcc, -1, v10
    v_mfma_f32_16x16x32_bf16 v[72:75], v[192:195], v[28:31], v[72:75]
    v_lshlrev_b32 v124, 16, v12
    v_and_b32 v125, 0xffff0000, v12
    v_lshlrev_b32 v126, 16, v13
    v_and_b32 v127, 0xffff0000, v13
    s_cbranch_vccnz L_or1_4
L_ob1_4:
    v_mfma_f32_16x16x32_bf16 v[56:59], v[196:199], v[32:35], v[56:59]
    v_mfma_f32_16x16x32_bf16 v[60:63], v[200:203], v[32:35], v[60:63]
    v_mfma_f32_16x16x32_bf16 v[64:67], v[204:207], v[32:35], v[64:67]
    v_mfma_f32_16x16x32_bf16 v[68:71], v[208:211], v[32:35], v[68:71]
    s_waitcnt vmcnt(3)
    v_max_u32 v10, v36, v38
    v_cmp_eq_u32 vcc, -1, v10
    v_mfma_f32_16x16x32_bf16 v[72:75], v[212:215], v[32:35], v[72:75]
    s_mul_i32 s58, s39, 3072
    s_add_u32 s58, s58, 102400
    v_add_u32 v128, s58, v9
    s_xor_b32 s58, s39, 2
    s_mul_i32 s58, s58, 3072
    s_add_u32 s58, s58, 102400
    v_add_u32 v129, s58, v9
    s_cbranch_vccnz L_or1_5
L_ob1_5:
    v_mfma_f32_16x16x32_bf16 v[56:59], v[216:219], v[36:39], v[56:59]
    v_mfma_f32_16x16x32_bf16 v[60:63], v[220:223], v[36:39], v[60:63]
    v_mfma_f32_16x16x32_bf16 v[64:67], v[224:227], v[36:39], v[64:67]
    v_mfma_f32_16x16x32_bf16 v[68:71], v[228:231], v[36:39], v[68:71]
    s_waitcnt vmcnt(2)
    v_max_u32 v10, v40, v42
    v_cmp_eq_u32 vcc, -1, v10
    v_mfma_f32_16x16x32_bf16 v[72:75], v[232:235], v[36:39], v[72:75]
    v_mov_b32 v130, s62
    v_mov_b32 v131, 1
    v_add_u32 v132, s88, v9
    s_cbranch_vccnz L_or1_6
L_ob1_6:
    v_mfma_f32_16x16x32_bf16 v[56:59], v[236:239], v[40:43], v[56:59]
    v_mfma_f32_16x16x32_bf16 v[60:63], v[240:243], v[40:43], v[60:63]
    v_mfma_f32_16x16x32_bf16 v[64:67], v[244:247], v[40:43], v[64:67]
    v_mfma_f32_16x16x32_bf16 v[68:71], v[248:251], v[40:43], v[68:71]
    s_waitcnt vmcnt(1)
    v_max_u32 v10, v48, v50
    v_cmp_eq_u32 vcc, -1, v10
    v_mfma_f32_16x16x32_bf16 v[72:75], v[252:255], v[40:43], v[72:75]
    ds_read_b128 v[16:19], v15 offset:0
    ds_read_b128 v[20:23], v15 offset:16
    ds_read_b128 v[24:27], v15 offset:32
    ds_read_b128 v[28:31], v15 offset:1280
    ds_read_b128 v[32:35], v15 offset:1296
    ds_read_b128 v[36:39], v15 offset:1312
    s_cbranch_vccnz L_or1_8
L_ob1_8:
    v_mfma_f32_16x16x32_bf16 v[56:59], v[96:99], v[48:51], v[56:59]
    v_mfma_f32_16x16x32_bf16 v[60:63], v[100:103], v[48:51], v[60:63]
    v_mfma_f32_16x16x32_bf16 v[64:67], v[104:107], v[48:51], v[64:67]
    v_mfma_f32_16x16x32_bf16 v[68:71], v[108:111], v[48:51], v[68:71]
    s_waitcnt vmcnt(0)
    v_max_u32 v10, v44, v46
    v_cmp_eq_u32 vcc, -1, v10
    v_mfma_f32_16x16x32_bf16 v[72:75], v[112:115], v[48:51], v[72:75]
    s_cbranch_vccnz L_or1_7
L_ob1_7:
    s_waitcnt lgkmcnt(6)
    v_mfma_f32_16x16x32_bf16 v[56:59], v[76:79], v[44:47], v[56:59]
    v_mfma_f32_16x16x32_bf16 v[60:63], v[80:83], v[44:47], v[60:63]
    v_mfma_f32_16x16x32_bf16 v[64:67], v[84:87], v[44:47], v[64:67]
    v_mfma_f32_16x16x32_bf16 v[68:71], v[88:91], v[44:47], v[68:71]
    v_mfma_f32_16x16x32_bf16 v[72:75], v[92:95], v[44:47], v[72:75]
    s_cmp_lg_u32 s71, 0
    s_cbranch_scc1 L_oe1
    s_nop 4
    ds_write_b128 v128, v[68:71] offset:0
    ds_write_b128 v128, v[72:75] offset:1024
    s_mov_b64 exec, 1
    ds_add_u32 v130, v131
    s_mov_b64 exec, -1
    s_waitcnt lgkmcnt(3)
L_epi0:
    v_pk_fma_f32 v[116:117], v[56:57], v[16:17], v[116:117]
    v_pk_fma_f32 v[118:119], v[58:59], v[18:19], v[118:119]
    v_pk_fma_f32 v[120:121], v[60:61], v[20:21], v[120:121]
    v_pk_fma_f32 v[122:123], v[62:63], v[22:23], v[122:123]
    v_pk_fma_f32 v[124:125], v[64:65], v[24:25], v[124:125]
    v_pk_fma_f32 v[126:127], v[66:67], v[26:27], v[126:127]
    s_mov_b32 s47, 1048576
L_lw_63:
    ds_read_b32 v55, v130
    s_waitcnt lgkmcnt(0)
    v_readfirstlane_b32 s63, v55
    s_nop 0
    s_cmp_ge_u32 s63, 2
    s_cbranch_scc1 L_lwr_64
    s_sub_u32 s47, s47, 1
    s_cbranch_scc0 L_lw_63
L_lwr_64:
    ds_read_b128 v[40:43], v129 offset:0
    ds_read_b128 v[44:47], v129 offset:1024
    ds_read_b128 v[48:51], v129 offset:2048
L_lwe_65:
    s_waitcnt lgkmcnt(2)
    v_pk_fma_f32 v[56:57], v[40:41], v[16:17], v[116:117]
    v_pk_mul_f32 v[70:71], v[56:57], v[56:57]
    v_pk_mul_f32 v[72:73], v[56:57], v[28:29]
    v_pk_fma_f32 v[58:59], v[42:43], v[18:19], v[118:119]
    v_pk_add_f32 v[68:69], v[56:57], v[58:59]
    v_pk_fma_f32 v[70:71], v[58:59], v[58:59], v[70:71]
    v_pk_fma_f32 v[72:73], v[58:59], v[30:31], v[72:73]
    s_waitcnt lgkmcnt(1)
    v_pk_fma_f32 v[60:61], v[44:45], v[20:21], v[120:121]
    v_pk_add_f32 v[68:69], v[68:69], v[60:61]
    v_pk_fma_f32 v[70:71], v[60:61], v[60:61], v[70:71]
    v_pk_fma_f32 v[72:73], v[60:61], v[32:33], v[72:73]
    v_pk_fma_f32 v[62:63], v[46:47], v[22:23], v[122:123]
    v_pk_add_f32 v[68:69], v[68:69], v[62:63]
    v_pk_fma_f32 v[70:71], v[62:63], v[62:63], v[70:71]
    v_pk_fma_f32 v[72:73], v[62:63], v[34:35], v[72:73]
    s_waitcnt lgkmcnt(0)
    v_pk_fma_f32 v[64:65], v[48:49], v[24:25], v[124:125]
    v_pk_add_f32 v[68:69], v[68:69], v[64:65]
    v_pk_fma_f32 v[70:71], v[64:65], v[64:65], v[70:71]
    v_pk_fma_f32 v[72:73], v[64:65], v[36:37], v[72:73]
    v_pk_fma_f32 v[66:67], v[50:51], v[26:27], v[126:127]
    v_pk_add_f32 v[68:69], v[68:69], v[66:67]
    v_pk_fma_f32 v[70:71], v[66:67], v[66:67], v[70:71]
    v_pk_fma_f32 v[72:73], v[66:67], v[38:39], v[72:73]
    s_branch L_oe2
L_oe1:
    s_nop 1
    ds_write_b128 v128, v[56:59] offset:0
    ds_write_b128 v128, v[60:63] offset:1024
    ds_write_b128 v128, v[64:67] offset:2048
    s_mov_b64 exec, 1
    ds_add_u32 v130, v131
    s_mov_b64 exec, -1
    s_waitcnt lgkmcnt(4)
L_epi1:
    v_pk_fma_f32 v[116:117], v[68:69], v[16:17], v[116:117]
    v_pk_fma_f32 v[118:119], v[70:71], v[18:19], v[118:119]
    v_pk_fma_f32 v[120:121], v[72:73], v[20:21], v[120:121]
    v_pk_fma_f32 v[122:123], v[74:75], v[22:23], v[122:123]
    s_mov_b32 s47, 1048576
L_lw_66:
    ds_read_b32 v55, v130
    s_waitcnt lgkmcnt(0)
    v_readfirstlane_b32 s63, v55
    s_nop 0
    s_cmp_ge_u32 s63, 2
    s_cbranch_scc1 L_lwr_67
    s_sub_u32 s47, s47, 1
    s_cbranch_scc0 L_lw_66
L_lwr_67:
    ds_read_b128 v[40:43], v129 offset:0
    ds_read_b128 v[44:47], v129 offset:1024
L_lwe_68:
    s_waitcnt lgkmcnt(1)
    v_pk_fma_f32 v[56:57], v[40:41], v[16:17], v[116:117]
    v_pk_mul_f32 v[70:71], v[56:57], v[56:57]
    v_pk_mul_f32 v[72:73], v[56:57], v[28:29]
    v_pk_fma_f32 v[58:59], v[42:43], v[18:19], v[118:119]
    v_pk_add_f32 v[68:69], v[56:57], v[58:59]
    v_pk_fma_f32 v[70:71], v[58:59], v[58:59], v[70:71]
    v_pk_fma_f32 v[72:73], v[58:59], v[30:31], v[72:73]
    s_waitcnt lgkmcnt(0)
    v_pk_fma_f32 v[60:61], v[44:45], v[20:21], v[120:121]
    v_pk_add_f32 v[68:69], v[68:69], v[60:61]
    v_pk_fma_f32 v[70:71], v[60:61], v[60:61], v[70:71]
    v_pk_fma_f32 v[72:73], v[60:61], v[32:33], v[72:73]
    v_pk_fma_f32 v[62:63], v[46:47], v[22:23], v[122:123]
    v_pk_add_f32 v[68:69], v[68:69], v[62:63]
    v_pk_fma_f32 v[70:71], v[62:63], v[62:63], v[70:71]
    v_pk_fma_f32 v[72:73], v[62:63], v[34:35], v[72:73]
L_oe2:
    v_add_f32 v16, v68, v69
    v_add_f32 v17, v70, v71
    v_add_f32 v18, v72, v73
    v_mov_b32 v19, s43
    v_permlane32_swap_b32 v16, v68
    v_permlane32_swap_b32 v17, v69
    v_permlane32_swap_b32 v18, v70
    v_pk_add_f32 v[16:17], v[16:17], v[68:69]
    v_add_f32 v18, v18, v70
    s_nop 0
    v_permlane16_swap_b32 v16, v68
    v_permlane16_swap_b32 v17, v69
    v_permlane16_swap_b32 v18, v70
    v_pk_add_f32 v[16:17], v[16:17], v[68:69]
    v_add_f32 v18, v18, v70
L_oe3:
    s_mov_b64 exec, 0xffff
    s_cmp_eq_u32 s91, 0
    s_cbranch_scc1 L_psg_69
    global_store_dwordx4 v132, v[16:19], s[36:37]
    s_branch L_pse_70
L_psg_69:
    global_store_dwordx4 v132, v[16:19], s[36:37] sc1
L_pse_70:
    s_mov_b64 exec, -1
    s_lshl_b32 s90, s41, 1
    s_add_u32 s90, s90, 1
    s_sub_u32 s90, s90, s40
    s_lshl_b32 s60, s90, 13
    s_lshl_b32 s61, s39, 10
    s_add_u32 s60, s60, s61
    s_add_u32 s60, s60, 3149824
    v_add_u32 v105, s60, v9
    v_mov_b32 v4, 162112
    ds_read_b128 v[76:79], v4 offset:0
    ds_read_b128 v[80:83], v4 offset:16
    ds_read_b128 v[84:87], v4 offset:32
    ds_read_b128 v[88:91], v4 offset:48
    ds_read_b128 v[92:95], v4 offset:64
    ds_read_b128 v[148:151], v15 offset:320
    ds_read_b128 v[152:155], v15 offset:336
    ds_read_b128 v[156:159], v15 offset:352
    ds_read_b128 v[160:163], v15 offset:640
    ds_read_b128 v[164:167], v15 offset:656
    ds_read_b128 v[168:171], v15 offset:672
    ds_read_b128 v[172:175], v15 offset:960
    ds_read_b128 v[176:179], v15 offset:976
    ds_read_b128 v[180:183], v15 offset:992
    global_load_dwordx4 v[112:115], v105, s[36:37] offset:-4096 sc1
    global_load_dwordx4 v[128:131], v105, s[36:37] offset:0 sc1
    v_mov_b32 v214, v11
    v_mov_b32 v206, 0
    v_mov_b32 v207, s43
    s_cmp_lg_u32 s70, 0
    s_cselect_b64 s[54:55], -1, 0
    s_mul_i32 s59, s90, 1280
    v_add_u32 v13, s59, v14
    v_lshlrev_b32 v12, 1, v13
    v_add_u32 v12, 3801088, v12
    v_add_u32 v13, 3686400, v13
    s_lshl_b32 s60, s90, 7
    s_add_u32 s60, s60, 102400
    v_add_u32 v4, s60, v9
    v_add_u32 v110, 0x2000, v4
    s_lshl_b32 s60, s38, 10
    s_add_u32 s60, s60, 118784
    v_add_u32 v106, s60, v9
    s_sub_u32 s60, s60, s61
    v_add_u32 v107, s60, v9
    v_mov_b32 v108, s72
    v_mov_b32 v109, 1
    s_add_u32 s45, s45, 4
    s_waitcnt lgkmcnt(9)
    v_pk_add_f32 v[76:77], v[76:77], v[78:79]
    v_pk_add_f32 v[80:81], v[80:81], v[82:83]
    v_pk_add_f32 v[84:85], v[84:85], v[86:87]
    v_pk_add_f32 v[88:89], v[88:89], v[90:91]
    v_pk_add_f32 v[92:93], v[92:93], v[94:95]
    v_pk_add_f32 v[76:77], v[76:77], v[80:81]
    v_pk_add_f32 v[84:85], v[84:85], v[88:89]
    v_pk_add_f32 v[76:77], v[76:77], v[92:93]
    v_pk_add_f32 v[76:77], v[76:77], v[84:85]
    v_add_f32 v100, v76, v77
    s_mov_b32 s47, 131072
    s_waitcnt vmcnt(0)
    s_branch L_plf_73
L_pl_71:
    global_load_dwordx4 v[112:115], v105, s[36:37] offset:-4096 sc1
    global_load_dwordx4 v[128:131], v105, s[36:37] offset:0 sc1
    s_waitcnt vmcnt(0)
L_plf_73:
    v_xor_b32 v5, s43, v115
    v_xor_b32 v6, s43, v131
    v_or_b32 v5, v5, v6
    v_cmp_ne_u32 vcc, 0, v5
    s_nop 0
    s_cbranch_vccz L_ple_72
    s_mov_b64 exec, vcc
    s_sub_u32 s47, s47, 1
    s_cbranch_scc0 L_pl_71
L_ple_72:
    s_mov_b64 exec, -1
    v_permlane16_swap_b32 v112, v128
    v_permlane16_swap_b32 v113, v129
    v_permlane16_swap_b32 v114, v130
    v_pk_add_f32 v[112:113], v[112:113], v[128:129]
    v_add_f32 v114, v114, v130
    ds_write_b128 v106, v[112:115]
    s_mov_b64 exec, 1
    ds_add_u32 v108, v109
    s_mov_b64 exec, -1
    s_mov_b32 s47, 1048576
L_lw_74:
    ds_read_b32 v5, v108
    s_waitcnt lgkmcnt(0)
    v_readfirstlane_b32 s63, v5
    s_nop 0
    s_cmp_ge_u32 s63, s45
    s_cbranch_scc1 L_lwr_75
    s_sub_u32 s47, s47, 1
    s_cbranch_scc0 L_lw_74
L_lwr_75:
    ds_read_b128 v[112:115], v107 offset:0
    ds_read_b128 v[116:119], v107 offset:1024
    ds_read_b128 v[120:123], v107 offset:2048
    ds_read_b128 v[124:127], v107 offset:3072
L_lwe_76:
    s_waitcnt lgkmcnt(2)
    v_pk_add_f32 v[112:113], v[112:113], v[116:117]
    v_add_f32 v114, v114, v118
    s_waitcnt lgkmcnt(0)
    v_pk_add_f32 v[120:121], v[120:121], v[124:125]
    v_add_f32 v122, v122, v126
    v_pk_add_f32 v[112:113], v[112:113], v[120:121]
    v_add_f32 v114, v114, v122
    v_mov_b64 v[128:129], v[112:113]
    v_mov_b32 v130, v114
    s_nop 0
    v_permlane32_swap_b32 v112, v128
    v_permlane32_swap_b32 v113, v129
    v_permlane32_swap_b32 v114, v130
    v_pk_add_f32 v[112:113], v[112:113], v[128:129]
    v_add_f32 v114, v114, v130
    v_mul_f32 v112, 0xbacccccd, v112
    v_mul_f32 v113, 0x3acccccd, v113
    v_fma_f32 v113, -v112, v112, v113
    v_max_f32 v113, 0, v113
    v_add_f32 v113, 0x3727c5ac, v113
    v_rsq_f32 v116, v113
    v_fmac_f32 v114, v112, v100
    v_mul_f32 v114, v114, v116
    v_mul_f32 v118, v112, v116
    v_mov_b32 v204, v114
    v_mov_b32 v5, v114
    v_mov_b32 v117, v116
    v_mov_b32 v119, v118
    v_permlane16_swap_b32 v204, v5
    v_permlane16_swap_b32 v116, v117
    v_max_f32 v204, v204, v5
    v_permlane16_swap_b32 v118, v119
    s_nop 0
    v_max_f32_dpp v204, v204, v204 row_ror:8 row_mask:0xf bank_mask:0xf
    v_cndmask_b32 v116, v116, v117, s[54:55]
    v_cndmask_b32 v118, v118, v119, s[54:55]
    v_max_f32_dpp v204, v204, v204 row_ror:4 row_mask:0xf bank_mask:0xf
    s_lshl_b32 s60, s90, 5
    s_or_b32 s59, s42, s39
    v_max_f32_dpp v204, v204, v204 row_ror:2 row_mask:0xf bank_mask:0xf
    s_lshl_b32 s61, s70, 4
    s_waitcnt lgkmcnt(0)
    v_max_f32_dpp v204, v204, v204 row_ror:1 row_mask:0xf bank_mask:0xf
    v_cmp_eq_f32 vcc, v114, v204
    s_nop 0
    s_ff1_i32_b32 s67, vcc_lo
    s_and_b32 s67, s67, 31
    s_cmp_lg_u32 s59, 0
    s_cbranch_scc1 L_nowin
    s_add_u32 s60, s60, s67
    v_mov_b32 v205, s60
    s_mov_b64 exec, 0xff
    global_store_dwordx4 v4, v[204:207], s[36:37] sc1
    global_store_dwordx4 v110, v[204:207], s[36:37]
    s_mov_b64 exec, -1
L_nowin:
    s_sub_u32 s59, s67, s61
    v_cmp_eq_u32 s[80:81], s59, v2
    v_pk_fma_f32 v[120:121], v[56:57], v[116:117], v[118:119] op_sel_hi:[1,0,0]
    v_pk_fma_f32 v[120:121], v[120:121], v[148:149], v[160:161]
    v_cvt_pk_bf16_f32 v196, v120, v121
    v_min_u32 v196, -2, v196
    v_pk_fma_f32 v[122:123], v[58:59], v[116:117], v[118:119] op_sel_hi:[1,0,0]
    v_pk_fma_f32 v[122:123], v[122:123], v[150:151], v[162:163]
    v_cvt_pk_bf16_f32 v197, v122, v123
    v_pk_fma_f32 v[124:125], v[60:61], v[116:117], v[118:119] op_sel_hi:[1,0,0]
    v_pk_fma_f32 v[124:125], v[124:125], v[152:153], v[164:165]
    v_cvt_pk_bf16_f32 v198, v124, v125
    v_min_u32 v198, -2, v198
    v_pk_fma_f32 v[126:127], v[62:63], v[116:117], v[118:119] op_sel_hi:[1,0,0]
    v_pk_fma_f32 v[126:127], v[126:127], v[154:155], v[166:167]
    v_cvt_pk_bf16_f32 v199, v126, v127
    v_pk_fma_f32 v[128:129], v[64:65], v[116:117], v[118:119] op_sel_hi:[1,0,0]
    v_pk_fma_f32 v[128:129], v[128:129], v[156:157], v[168:169]
    v_cvt_pk_bf16_f32 v200, v128, v129
    v_min_u32 v200, -2, v200
    v_pk_fma_f32 v[130:131], v[66:67], v[116:117], v[118:119] op_sel_hi:[1,0,0]
    v_pk_fma_f32 v[130:131], v[130:131], v[158:159], v[170:171]
    v_cvt_pk_bf16_f32 v201, v130, v131
    s_and_saveexec_b64 s[52:53], s[80:81]
    s_cbranch_execz L_noh2
    global_store_dwordx4 v13, v[196:199], s[36:37] sc1
    s_cmp_lg_u32 s71, 0
    s_cbranch_scc1 L_noh2
    global_store_dwordx2 v13, v[200:201], s[36:37] offset:16 sc1
L_noh2:
    s_mov_b64 exec, -1
    v_pk_fma_f32 v[56:57], v[120:121], v[172:173], v[56:57]
    v_cvt_pk_bf16_f32 v208, v56, v57
    v_min_u32 v56, -2, v56
    v_pk_fma_f32 v[58:59], v[122:123], v[174:175], v[58:59]
    v_cvt_pk_bf16_f32 v209, v58, v59
    v_pk_fma_f32 v[60:61], v[124:125], v[176:177], v[60:61]
    v_cvt_pk_bf16_f32 v210, v60, v61
    v_min_u32 v60, -2, v60
    v_pk_fma_f32 v[62:63], v[126:127], v[178:179], v[62:63]
    v_cvt_pk_bf16_f32 v211, v62, v63
    v_pk_fma_f32 v[64:65], v[128:129], v[180:181], v[64:65]
    v_cvt_pk_bf16_f32 v212, v64, v65
    v_min_u32 v64, -2, v64
    v_pk_fma_f32 v[66:67], v[130:131], v[182:183], v[66:67]
    v_cvt_pk_bf16_f32 v213, v66, v67
    s_and_saveexec_b64 s[52:53], s[80:81]
    s_cbranch_execz L_nobase
    global_store_dwordx4 v12, v[56:59], s[36:37] sc1
    global_store_dwordx4 v12, v[60:63], s[36:37] offset:16 sc1
    s_cmp_lg_u32 s71, 0
    s_cbranch_scc1 L_nobase
    global_store_dwordx4 v12, v[64:67], s[36:37] offset:32 sc1
L_nobase:
    s_mov_b64 exec, -1
    s_cmp_ge_u32 s97, 108
    s_cbranch_scc1 L_ffn2
    s_and_b32 s58, s38, 6
    s_cmp_eq_u32 s58, 4
    s_cbranch_scc1 L_ffn1
    s_barrier
    s_barrier
L_rows:
    s_not_b64 exec, s[80:81]
    global_store_dwordx4 v214, v[208:211], s[32:33]
    s_cmp_lg_u32 s71, 0
    s_cbranch_scc1 L_or_77
    global_store_dwordx2 v214, v[212:213], s[32:33] offset:16
L_or_77:
    s_mov_b64 exec, -1
    s_endpgm
L_ffn1:
    v_lshlrev_b32 v8, 7, v1
    v_add_u32 v8, 102400, v8
    v_cmp_eq_u64 vcc, v[228:229], v[238:239]
    v_add_u32 v9, 0x2000, v8
    s_nop 0
    v_cndmask_b32 v8, v8, v9, vcc
    v_lshlrev_b32 v14, 8, v3
    v_lshl_add_u32 v14, v2, 3, v14
    v_and_b32 v4, 2, v2
    v_mul_u32_u24 v4, 25592, v4
    s_lshl_b32 s58, s70, 4
    v_add3_u32 v14, v14, v4, s58
    v_lshlrev_b32 v12, 4, v3
    v_add_u32 v12, 3686400, v12
    v_and_b32 v13, 3, v2
    v_lshl_add_u32 v13, v13, 6, v12
    v_add_u32 v13, 1024, v13
    v_lshl_add_u32 v12, v2, 6, v12
    s_lshl_b32 s58, s97, 1
    s_add_u32 s58, s58, s70
    s_lshl_b32 s58, s58, 7
    s_add_u32 s58, s58, 3997696
    v_lshl_add_u32 v15, v2, 1, s58
    s_setprio 3
    s_barrier
    s_mov_b32 s47, 131072
    global_load_dwordx4 v[4:7], v8, s[36:37] sc1
    ds_read_b64_tr_b16 v[16:17], v14 offset:0
    ds_read_b64_tr_b16 v[18:19], v14 offset:128
    ds_read_b64_tr_b16 v[20:21], v14 offset:1024
    ds_read_b64_tr_b16 v[22:23], v14 offset:1152
    ds_read_b64_tr_b16 v[24:25], v14 offset:2048
    ds_read_b64_tr_b16 v[26:27], v14 offset:2176
    ds_read_b64_tr_b16 v[28:29], v14 offset:3072
    ds_read_b64_tr_b16 v[30:31], v14 offset:3200
    ds_read_b64_tr_b16 v[32:33], v14 offset:4096
    ds_read_b64_tr_b16 v[34:35], v14 offset:4224
    ds_read_b64_tr_b16 v[36:37], v14 offset:5120
    ds_read_b64_tr_b16 v[38:39], v14 offset:5248
    ds_read_b64_tr_b16 v[40:41], v14 offset:6144
    ds_read_b64_tr_b16 v[42:43], v14 offset:6272
    ds_read_b64_tr_b16 v[44:45], v14 offset:7168
    ds_read_b64_tr_b16 v[46:47], v14 offset:7296
    ds_read_b64_tr_b16 v[48:49], v14 offset:8192
    ds_read_b64_tr_b16 v[50:51], v14 offset:8320
    ds_read_b64_tr_b16 v[52:53], v14 offset:9216
    ds_read_b64_tr_b16 v[54:55], v14 offset:9344
    ds_read_b64_tr_b16 v[56:57], v14 offset:10240
    ds_read_b64_tr_b16 v[58:59], v14 offset:10368
    ds_read_b64_tr_b16 v[60:61], v14 offset:11264
    ds_read_b64_tr_b16 v[62:63], v14 offset:11392
    ds_read_b64_tr_b16 v[64:65], v14 offset:12288
    ds_read_b64_tr_b16 v[66:67], v14 offset:12416
    ds_read_b64_tr_b16 v[68:69], v14 offset:13312
    ds_read_b64_tr_b16 v[70:71], v14 offset:13440
    ds_read_b64_tr_b16 v[72:73], v14 offset:14336
    ds_read_b64_tr_b16 v[74:75], v14 offset:14464
    ds_read_b64_tr_b16 v[76:77], v14 offset:15360
    ds_read_b64_tr_b16 v[78:79], v14 offset:15488
    ds_read_b64_tr_b16 v[80:81], v14 offset:16384
    ds_read_b64_tr_b16 v[82:83], v14 offset:16512
    ds_read_b64_tr_b16 v[84:85], v14 offset:17408
    ds_read_b64_tr_b16 v[86:87], v14 offset:17536
    ds_read_b64_tr_b16 v[88:89], v14 offset:18432
    ds_read_b64_tr_b16 v[90:91], v14 offset:18560
    ds_read_b64_tr_b16 v[92:93], v14 offset:19456
    ds_read_b64_tr_b16 v[94:95], v14 offset:19584
    s_branch L_pm_78_w
L_pm_78:
    global_load_dwordx4 v[4:7], v8, s[36:37] sc1
L_pm_78_w:
    s_waitcnt vmcnt(0)
    v_cmp_ne_u32 vcc, s43, v7
    s_nop 0
    s_cbranch_vccz L_pme_79
    s_mov_b64 exec, vcc
    s_sub_u32 s47, s47, 1
    s_cbranch_scc0 L_pm_78
L_pme_79:
    s_mov_b64 exec, -1
    v_mov_b32 v9, v4
    s_nop 1
    v_max_f32_dpp v9, v9, v9 row_ror:8 row_mask:0xf bank_mask:0xf
    s_nop 1
    v_max_f32_dpp v9, v9, v9 row_ror:4 row_mask:0xf bank_mask:0xf
    s_nop 1
    v_max_f32_dpp v9, v9, v9 row_ror:2 row_mask:0xf bank_mask:0xf
    s_nop 1
    v_max_f32_dpp v9, v9, v9 row_ror:1 row_mask:0xf bank_mask:0xf
    v_mov_b32 v10, v9
    s_nop 1
    v_permlane32_swap_b32 v10, v9
    v_max_f32 v9, v10, v9
    v_mov_b32 v10, v9
    s_nop 1
    v_permlane16_swap_b32 v10, v9
    v_max_f32 v9, v10, v9
    v_cmp_eq_f32 vcc, v4, v9
    s_nop 0
    s_ff1_i32_b64 s61, vcc
    s_and_b32 s61, s61, 63
    v_readlane_b32 s67, v5, s61
    v_readlane_b32 s66, v4, s61
    s_mul_i32 s58, s61, 1280
    v_add_u32 v12, s58, v12
    v_add_u32 v13, s58, v13
    s_mov_b32 s47, 131072
L_pv_80:
    global_load_dwordx4 v[96:99], v12, s[36:37] sc1
    global_load_dwordx4 v[100:103], v13, s[36:37] sc1
    s_waitcnt vmcnt(0)
    v_max_u32 v10, v96, v98
    v_max3_u32 v10, v10, v100, v102
    v_cmp_eq_u32 vcc, -1, v10
    s_nop 0
    s_cbranch_vccz L_pve_81
    s_mov_b64 exec, vcc
    s_sub_u32 s47, s47, 1
    s_cbranch_scc0 L_pv_80
L_pve_81:
    s_mov_b64 exec, -1
    s_waitcnt lgkmcnt(0)
    v_mfma_f32_16x16x32_bf16 v[112:115], v[96:99], v[16:19], 0
    v_mfma_f32_16x16x32_bf16 v[116:119], v[96:99], v[20:23], 0
    v_mfma_f32_16x16x32_bf16 v[120:123], v[96:99], v[24:27], 0
    v_mfma_f32_16x16x32_bf16 v[124:127], v[96:99], v[28:31], 0
    v_mfma_f32_16x16x32_bf16 v[112:115], v[100:103], v[80:83], v[112:115]
    v_mfma_f32_16x16x32_bf16 v[116:119], v[100:103], v[84:87], v[116:119]
    v_mfma_f32_16x16x32_bf16 v[120:123], v[100:103], v[88:91], v[120:123]
    v_mfma_f32_16x16x32_bf16 v[124:127], v[100:103], v[92:95], v[124:127]
    v_mfma_f32_16x16x32_bf16 v[128:131], v[96:99], v[32:35], 0
    v_mfma_f32_16x16x32_bf16 v[132:135], v[96:99], v[36:39], 0
    v_mfma_f32_16x16x32_bf16 v[136:139], v[96:99], v[40:43], 0
    v_mfma_f32_16x16x32_bf16 v[140:143], v[96:99], v[44:47], 0
    v_mfma_f32_16x16x32_bf16 v[144:147], v[96:99], v[48:51], 0
    v_mfma_f32_16x16x32_bf16 v[148:151], v[96:99], v[52:55], 0
    v_mfma_f32_16x16x32_bf16 v[152:155], v[96:99], v[56:59], 0
    v_mfma_f32_16x16x32_bf16 v[156:159], v[96:99], v[60:63], 0
    v_add_f32 v112, v112, v122
    v_mfma_f32_16x16x32_bf16 v[160:163], v[96:99], v[64:67], 0
    v_add_f32 v117, v117, v127
    v_mfma_f32_16x16x32_bf16 v[164:167], v[96:99], v[68:71], 0
    s_nop 0
    v_add_f32_dpp v176, v112, v117 quad_perm:[0,1,2,3] row_mask:0x1 bank_mask:0xf
    v_mfma_f32_16x16x32_bf16 v[168:171], v[96:99], v[72:75], 0
    v_mfma_f32_16x16x32_bf16 v[172:175], v[96:99], v[76:79], 0
    v_add_f32 v128, v128, v138
    v_add_f32 v133, v133, v143
    v_add_f32 v144, v144, v154
    v_add_f32 v149, v149, v159
    v_add_f32_dpp v176, v128, v133 quad_perm:[0,1,2,3] row_mask:0x2 bank_mask:0xf
    s_nop 1
    v_add_f32 v160, v160, v170
    v_add_f32 v165, v165, v175
    v_add_f32_dpp v176, v144, v149 quad_perm:[0,1,2,3] row_mask:0x4 bank_mask:0xf
    s_nop 1
    v_add_f32_dpp v176, v160, v165 quad_perm:[0,1,2,3] row_mask:0x8 bank_mask:0xf
    v_mov_b32 v177, v176
    s_nop 1
    v_permlane32_swap_b32 v177, v176
    v_add_f32 v176, v177, v176
    v_mov_b32 v177, v176
    s_nop 1
    v_permlane16_swap_b32 v177, v176
    v_add_f32 v176, v177, v176
    v_mul_f32 v177, 0xbfb8aa3b, v176
    v_exp_f32 v177, v177
    v_mul_f32_dpp v178, v176, v176 row_ror:8 row_mask:0xf bank_mask:0xf
    v_add_f32 v177, 1.0, v177
    v_rcp_f32 v177, v177
    s_mov_b64 exec, 0xff
    v_mul_f32 v178, v178, v177
    s_nop 1
    v_mov_b32_dpp v179, v178 quad_perm:[1,1,3,3] row_mask:0xf bank_mask:0xf
    s_mov_b64 exec, 0x55
    v_cvt_pk_bf16_f32 v12, v178, v179
    v_min_u32 v12, -2, v12
    global_store_dword v15, v12, s[36:37] sc1
    s_mov_b64 exec, -1
    s_barrier
    s_cmp_lg_u32 s97, 0
    s_cbranch_scc1 L_rows
    v_mov_b32 v4, 0
    v_mov_b32 v5, s43
    s_mov_b64 exec, 1
    global_store_dword v4, v5, s[36:37]
    s_branch L_rows
L_ffn2:
    s_cmp_lt_u32 s97, 148
    s_cselect_b32 s58, s40, 0
    s_cmp_lg_u32 s58, 0
    s_cbranch_scc1 L_ffn2B
    s_barrier
    s_branch L_rows
L_ffn2B:
    v_lshlrev_b32 v8, 7, v1
    v_add_u32 v8, 102400, v8
    v_cmp_eq_u64 vcc, v[228:229], v[238:239]
    v_add_u32 v9, 0x2000, v8
    s_nop 0
    v_cndmask_b32 v8, v8, v9, vcc
    v_lshlrev_b32 v14, 8, v3
    v_lshl_add_u32 v14, v2, 3, v14
    s_sub_u32 s88, s97, 108
    s_mul_i32 s89, s39, 14
    s_min_u32 s89, s89, 40
    s_and_b32 s59, s39, 1
    s_mul_i32 s59, s59, 14336
    s_lshr_b32 s60, s39, 1
    s_mul_i32 s60, s60, 51200
    s_add_u32 s60, s60, s59
    v_add_u32 v14, s60, v14
    s_lshl_b32 s58, s88, 6
    s_add_u32 s58, s58, 4070912
    v_lshl_add_u32 v12, v2, 2, s58
    global_load_dword v188, v12, s[36:37] sc1
    v_min_u32 v12, 4, v2
    v_lshlrev_b32 v12, 4, v12
    v_add_u32 v12, 4096080, v12
    global_load_dwordx4 v[96:99], v12, s[36:37] sc1
    ds_read_b64_tr_b16 v[16:17], v14 offset:0
    ds_read_b64_tr_b16 v[18:19], v14 offset:128
    ds_read_b64_tr_b16 v[20:21], v14 offset:1024
    ds_read_b64_tr_b16 v[22:23], v14 offset:1152
    ds_read_b64_tr_b16 v[24:25], v14 offset:2048
    ds_read_b64_tr_b16 v[26:27], v14 offset:2176
    ds_read_b64_tr_b16 v[28:29], v14 offset:3072
    ds_read_b64_tr_b16 v[30:31], v14 offset:3200
    ds_read_b64_tr_b16 v[32:33], v14 offset:4096
    ds_read_b64_tr_b16 v[34:35], v14 offset:4224
    ds_read_b64_tr_b16 v[36:37], v14 offset:5120
    ds_read_b64_tr_b16 v[38:39], v14 offset:5248
    ds_read_b64_tr_b16 v[40:41], v14 offset:6144
    ds_read_b64_tr_b16 v[42:43], v14 offset:6272
    ds_read_b64_tr_b16 v[44:45], v14 offset:7168
    ds_read_b64_tr_b16 v[46:47], v14 offset:7296
    ds_read_b64_tr_b16 v[48:49], v14 offset:8192
    ds_read_b64_tr_b16 v[50:51], v14 offset:8320
    ds_read_b64_tr_b16 v[52:53], v14 offset:9216
    ds_read_b64_tr_b16 v[54:55], v14 offset:9344
    ds_read_b64_tr_b16 v[56:57], v14 offset:10240
    ds_read_b64_tr_b16 v[58:59], v14 offset:10368
    ds_read_b64_tr_b16 v[60:61], v14 offset:11264
    ds_read_b64_tr_b16 v[62:63], v14 offset:11392
    ds_read_b64_tr_b16 v[64:65], v14 offset:12288
    ds_read_b64_tr_b16 v[66:67], v14 offset:12416
    ds_read_b64_tr_b16 v[68:69], v14 offset:13312
    ds_read_b64_tr_b16 v[70:71], v14 offset:13440
    s_waitcnt lgkmcnt(0)
    s_cmp_lg_u32 s39, 3
    s_cbranch_scc1 L_f2full
    v_mov_b32 v16, 0
    v_mov_b32 v17, 0
    v_mov_b32 v18, 0
    v_mov_b32 v19, 0
    v_mov_b32 v20, 0
    v_mov_b32 v21, 0
    v_mov_b32 v22, 0
    v_mov_b32 v23, 0
L_f2full:
    v_cmp_gt_u32 vcc, 5, v2
    s_waitcnt vmcnt(0)
    v_pk_add_f32 v[96:97], v[96:97], v[98:99]
    v_add_f32 v96, v96, v97
    v_cndmask_b32 v189, 0, v96, vcc
    s_nop 1
    v_add_f32_dpp v189, v189, v189 row_ror:8 row_mask:0xf bank_mask:0xf
    s_nop 1
    v_add_f32_dpp v189, v189, v189 row_ror:4 row_mask:0xf bank_mask:0xf
    s_nop 1
    v_add_f32_dpp v189, v189, v189 row_ror:2 row_mask:0xf bank_mask:0xf
    s_nop 1
    v_add_f32_dpp v189, v189, v189 row_ror:1 row_mask:0xf bank_mask:0xf
    s_barrier
    s_mov_b32 s47, 131072
L_pm_82:
    global_load_dwordx4 v[4:7], v8, s[36:37] sc1
    s_waitcnt vmcnt(0)
    v_cmp_ne_u32 vcc, s43, v7
    s_nop 0
    s_cbranch_vccz L_pme_83
    s_mov_b64 exec, vcc
    s_sub_u32 s47, s47, 1
    s_cbranch_scc0 L_pm_82
L_pme_83:
    s_mov_b64 exec, -1
    v_mov_b32 v9, v4
    s_nop 1
    v_max_f32_dpp v9, v9, v9 row_ror:8 row_mask:0xf bank_mask:0xf
    s_nop 1
    v_max_f32_dpp v9, v9, v9 row_ror:4 row_mask:0xf bank_mask:0xf
    s_nop 1
    v_max_f32_dpp v9, v9, v9 row_ror:2 row_mask:0xf bank_mask:0xf
    s_nop 1
    v_max_f32_dpp v9, v9, v9 row_ror:1 row_mask:0xf bank_mask:0xf
    v_mov_b32 v10, v9
    s_nop 1
    v_permlane32_swap_b32 v10, v9
    v_max_f32 v9, v10, v9
    v_mov_b32 v10, v9
    s_nop 1
    v_permlane16_swap_b32 v10, v9
    v_max_f32 v9, v10, v9
    v_cmp_eq_f32 vcc, v4, v9
    s_nop 0
    s_ff1_i32_b64 s61, vcc
    s_and_b32 s61, s61, 63
    v_readlane_b32 s67, v5, s61
    v_readlane_b32 s66, v4, s61
    s_lshl_b32 s58, s39, 4
    v_add_u32 v8, s58, v2
    v_lshlrev_b32 v9, 2, v8
    ds_bpermute_b32 v10, v9, v5
    v_cmp_ne_u32 s[78:79], s61, v8
    v_mul_u32_u24 v8, 2560, v8
    s_lshl_b32 s58, s88, 6
    s_add_u32 s58, s58, 3801088
    v_lshl_add_u32 v9, v3, 4, s58
    v_add_u32 v8, v9, v8
    s_mul_i32 s59, s61, 2560
    s_add_u32 s58, s58, s59
    v_lshl_add_u32 v9, v2, 2, s58
    s_lshl_b32 s58, s88, 5
    v_lshl_add_u32 v11, v3, 3, s58
    s_waitcnt lgkmcnt(0)
    v_and_b32 v10, 2047, v10
    v_mul_u32_u24 v10, 1280, v10
    v_add_u32 v15, v11, v10
    s_and_b32 s67, s67, 2047
    s_mul_i32 s59, s67, 1280
    s_add_u32 s58, s58, s59
    v_lshl_add_u32 v11, v2, 1, s58
    s_mov_b32 s47, 131072
L_pl_84:
    global_load_dwordx4 v[196:199], v8, s[36:37] sc1
    global_load_dword v200, v9, s[36:37] sc1
    s_waitcnt vmcnt(0)
    v_mov_b32_dpp v201, v200 quad_perm:[0,0,0,0] row_mask:0xf bank_mask:0xf
    v_max_u32 v10, v196, v201
    v_cmp_eq_u32 vcc, -1, v10
    s_nop 0
    s_cbranch_vccz L_ple_85
    s_sub_u32 s47, s47, 1
    s_cbranch_scc0 L_pl_84
L_ple_85:
    v_cvt_pk_bf16_f32 v12, v196, v197
    v_cvt_pk_bf16_f32 v13, v198, v199
    s_mov_b64 exec, s[78:79]
    global_store_dwordx2 v15, v[12:13], s[32:33]
    s_mov_b64 exec, -1
    v_add_f32 v204, s66, v189
    v_mul_f32 v204, 0xbfb8aa3b, v204
    v_exp_f32 v204, v204
    s_lshl_b32 s58, s89, 9
    s_add_u32 s58, s58, 3997696
    v_add_f32 v204, 1.0, v204
    v_rcp_f32 v204, v204
    v_min_u32 v8, 13, v2
    v_lshl_add_u32 v8, v8, 2, v3
    v_lshl_add_u32 v8, v8, 7, s58
    v_mul_f32 v204, v204, v188
    s_lshl_b32 s58, s39, 2
    s_add_u32 s58, s58, 162304
    v_lshl_add_u32 v9, v2, 4, s58
    s_not_b64 exec, s[80:81]
    global_store_dwordx4 v214, v[208:211], s[32:33]
    s_cmp_lg_u32 s71, 0
    s_cbranch_scc1 L_or_87
    global_store_dwordx2 v214, v[212:213], s[32:33] offset:16
L_or_87:
    s_mov_b64 exec, -1
    s_waitcnt vmcnt(0)
    s_mov_b32 s47, 131072
L_pv_88:
    global_load_dwordx4 v[96:99], v8, s[36:37] sc1
    s_waitcnt vmcnt(0)
    v_max_u32 v10, v96, v97
    v_max3_u32 v10, v10, v98, v99
    v_cmp_eq_u32 vcc, -1, v10
    s_nop 0
    s_cbranch_vccz L_pve_89
    s_mov_b64 exec, vcc
    s_sub_u32 s47, s47, 1
    s_cbranch_scc0 L_pv_88
L_pve_89:
    s_mov_b64 exec, -1
    v_mfma_f32_16x16x32_bf16 v[112:115], v[96:99], v[16:19], 0
    v_mfma_f32_16x16x32_bf16 v[116:119], v[96:99], v[20:23], 0
    v_mfma_f32_16x16x32_bf16 v[120:123], v[96:99], v[24:27], 0
    v_mfma_f32_16x16x32_bf16 v[124:127], v[96:99], v[28:31], 0
    v_mfma_f32_16x16x32_bf16 v[128:131], v[96:99], v[32:35], 0
    v_mfma_f32_16x16x32_bf16 v[132:135], v[96:99], v[36:39], 0
    v_mfma_f32_16x16x32_bf16 v[136:139], v[96:99], v[40:43], 0
    v_mfma_f32_16x16x32_bf16 v[140:143], v[96:99], v[44:47], 0
    v_mfma_f32_16x16x32_bf16 v[144:147], v[96:99], v[48:51], 0
    v_mfma_f32_16x16x32_bf16 v[148:151], v[96:99], v[52:55], 0
    v_mfma_f32_16x16x32_bf16 v[152:155], v[96:99], v[56:59], 0
    v_mfma_f32_16x16x32_bf16 v[156:159], v[96:99], v[60:63], 0
    v_add_f32 v112, v112, v122
    v_mfma_f32_16x16x32_bf16 v[160:163], v[96:99], v[64:67], 0
    v_add_f32 v117, v117, v127
    v_mfma_f32_16x16x32_bf16 v[164:167], v[96:99], v[68:71], 0
    s_nop 0
    v_add_f32_dpp v176, v112, v117 quad_perm:[0,1,2,3] row_mask:0x1 bank_mask:0xf
    v_add_f32 v128, v128, v138
    v_add_f32 v133, v133, v143
    v_add_f32 v144, v144, v154
    v_add_f32 v149, v149, v159
    v_add_f32_dpp v176, v128, v133 quad_perm:[0,1,2,3] row_mask:0x2 bank_mask:0xf
    s_nop 1
    v_add_f32_dpp v176, v144, v149 quad_perm:[0,1,2,3] row_mask:0x4 bank_mask:0xf
    s_nop 1
    v_add_f32_dpp v176, v160, v165 quad_perm:[0,1,2,3] row_mask:0x8 bank_mask:0xf
    v_mov_b32 v177, v176
    s_nop 1
    v_permlane32_swap_b32 v177, v176
    v_add_f32 v176, v177, v176
    v_mov_b32 v177, v176
    s_nop 1
    v_permlane16_swap_b32 v177, v176
    v_add_f32 v176, v177, v176
    ds_write_b32 v9, v176
    s_waitcnt lgkmcnt(0)
    s_barrier
    s_cmp_lg_u32 s39, 0
    s_cbranch_scc1 L_end
    ds_read_b128 v[180:183], v9
    s_waitcnt lgkmcnt(0)
    v_pk_add_f32 v[180:181], v[180:181], v[182:183]
    v_add_f32 v180, v180, v181
    v_fmac_f32 v200, v180, v204
    s_nop 1
    v_mov_b32_dpp v201, v200 quad_perm:[1,1,3,3] row_mask:0xf bank_mask:0xf
    s_mov_b64 exec, 0x5555
    v_cvt_pk_bf16_f32 v12, v200, v201
    global_store_dword v11, v12, s[32:33]
    s_mov_b64 exec, -1
L_end:
    s_endpgm
L_exit:
    s_endpgm
L_ffn:
    s_barrier
    v_mov_b32 v9, v240
    v_mul_u32_u24 v15, 80, v3
    s_mul_i32 s58, s71, 48
    s_add_u32 s58, s58, 160512
    v_add_u32 v15, s58, v15
    s_lshl_b32 s60, s41, 14
    s_lshl_b32 s61, s70, 12
    s_add_u32 s60, s60, s61
    s_lshl_b32 s61, s42, 9
    s_add_u32 s60, s60, s61
    s_lshl_b32 s61, s71, 8
    s_add_u32 s60, s60, s61
    s_add_u32 s88, s60, 3145728
    s_mov_b32 s62, 160300
    v_mov_b32 v11, v230
    v_mov_b32 v14, v231
    s_xor_b32 s60, s39, 0
    s_mul_i32 s58, s60, 3072
    s_add_u32 s58, s58, 143360
    s_lshr_b32 s60, s60, 1
    s_mul_i32 s60, s60, 51200
    s_lshl_b32 s59, s70, 11
    s_add_u32 s59, s59, s60
    s_add_u32 s59, s59, 28672
    v_add_u32 v4, s58, v9
    v_add_u32 v5, s59, v9
    s_xor_b32 s60, s39, 2
    s_mul_i32 s58, s60, 3072
    s_add_u32 s58, s58, 143360
    s_lshr_b32 s60, s60, 1
    s_mul_i32 s60, s60, 51200
    s_lshl_b32 s59, s70, 11
    s_add_u32 s59, s59, s60
    s_add_u32 s59, s59, 28672
    v_add_u32 v129, s58, v9
    v_add_u32 v53, s59, v9
    ds_read_b128 v[16:19], v15 offset:0
    ds_read_b128 v[20:23], v15 offset:16
    ds_read_b128 v[24:27], v15 offset:32
    ds_read_b128 v[28:31], v15 offset:1280
    ds_read_b128 v[32:35], v15 offset:1296
    ds_read_b128 v[36:39], v15 offset:1312
    v_mov_b32 v130, s62
    v_mov_b32 v131, 1
    v_add_u32 v132, s88, v9
    s_cmp_lg_u32 s71, 0
    s_cbranch_scc1 L_g01
    ds_read_b128 v[56:59], v4 offset:0
    ds_read_b128 v[60:63], v4 offset:1024
    ds_read_b128 v[64:67], v4 offset:2048
    v_lshlrev_b32 v116, 16, v232
    v_and_b32 v117, 0xffff0000, v232
    v_lshlrev_b32 v118, 16, v233
    v_and_b32 v119, 0xffff0000, v233
    v_lshlrev_b32 v120, 16, v234
    v_and_b32 v121, 0xffff0000, v234
    v_lshlrev_b32 v122, 16, v235
    v_and_b32 v123, 0xffff0000, v235
    v_lshlrev_b32 v124, 16, v236
    v_and_b32 v125, 0xffff0000, v236
    v_lshlrev_b32 v126, 16, v237
    v_and_b32 v127, 0xffff0000, v237
    s_waitcnt lgkmcnt(0)
    s_branch L_epi0
L_g01:
    v_mov_b32 v129, v53
    ds_read_b128 v[68:71], v5 offset:0
    ds_read_b128 v[72:75], v5 offset:1024
    v_lshlrev_b32 v116, 16, v232
    v_and_b32 v117, 0xffff0000, v232
    v_lshlrev_b32 v118, 16, v233
    v_and_b32 v119, 0xffff0000, v233
    v_lshlrev_b32 v120, 16, v234
    v_and_b32 v121, 0xffff0000, v234
    v_lshlrev_b32 v122, 16, v235
    v_and_b32 v123, 0xffff0000, v235
    s_waitcnt lgkmcnt(0)
    s_branch L_epi1
L_or1_9:
    global_load_dwordx4 v[52:55], v9, s[100:101] offset:-3072 sc1
    s_waitcnt vmcnt(0)
    v_max_u32 v10, v52, v54
    v_cmp_eq_u32 vcc, -1, v10
    s_nop 0
    s_cbranch_vccz L_of1_9
    s_sub_u32 s47, s47, 1
    s_cbranch_scc0 L_or1_9
L_of1_9:
    global_load_dwordx4 v[16:19], v9, s[98:99] offset:-4096 sc1
    global_load_dwordx4 v[20:23], v9, s[98:99] offset:-3072 sc1
    global_load_dwordx4 v[24:27], v9, s[98:99] offset:-2048 sc1
    global_load_dwordx4 v[28:31], v9, s[98:99] offset:-1024 sc1
    global_load_dwordx4 v[32:35], v9, s[98:99] offset:0 sc1
    global_load_dwordx4 v[36:39], v9, s[98:99] offset:1024 sc1
    global_load_dwordx4 v[40:43], v9, s[98:99] offset:2048 sc1
    global_load_dwordx4 v[48:51], v9, s[100:101] offset:-4096 sc1
    global_load_dwordx4 v[44:47], v9, s[98:99] offset:3072 sc1
    s_branch L_ob1_9
L_or1_0:
    global_load_dwordx4 v[16:19], v9, s[98:99] offset:-4096 sc1
    s_waitcnt vmcnt(0)
    v_max_u32 v10, v16, v18
    v_cmp_eq_u32 vcc, -1, v10
    s_nop 0
    s_cbranch_vccz L_of1_0
    s_sub_u32 s47, s47, 1
    s_cbranch_scc0 L_or1_0
L_of1_0:
    global_load_dwordx4 v[20:23], v9, s[98:99] offset:-3072 sc1
    global_load_dwordx4 v[24:27], v9, s[98:99] offset:-2048 sc1
    global_load_dwordx4 v[28:31], v9, s[98:99] offset:-1024 sc1
    global_load_dwordx4 v[32:35], v9, s[98:99] offset:0 sc1
    global_load_dwordx4 v[36:39], v9, s[98:99] offset:1024 sc1
    global_load_dwordx4 v[40:43], v9, s[98:99] offset:2048 sc1
    global_load_dwordx4 v[48:51], v9, s[100:101] offset:-4096 sc1
    global_load_dwordx4 v[44:47], v9, s[98:99] offset:3072 sc1
    s_branch L_ob1_0
L_or1_1:
    global_load_dwordx4 v[20:23], v9, s[98:99] offset:-3072 sc1
    s_waitcnt vmcnt(0)
    v_max_u32 v10, v20, v22
    v_cmp_eq_u32 vcc, -1, v10
    s_nop 0
    s_cbranch_vccz L_of1_1
    s_sub_u32 s47, s47, 1
    s_cbranch_scc0 L_or1_1
L_of1_1:
    global_load_dwordx4 v[24:27], v9, s[98:99] offset:-2048 sc1
    global_load_dwordx4 v[28:31], v9, s[98:99] offset:-1024 sc1
    global_load_dwordx4 v[32:35], v9, s[98:99] offset:0 sc1
    global_load_dwordx4 v[36:39], v9, s[98:99] offset:1024 sc1
    global_load_dwordx4 v[40:43], v9, s[98:99] offset:2048 sc1
    global_load_dwordx4 v[48:51], v9, s[100:101] offset:-4096 sc1
    global_load_dwordx4 v[44:47], v9, s[98:99] offset:3072 sc1
    s_branch L_ob1_1
L_or1_2:
    global_load_dwordx4 v[24:27], v9, s[98:99] offset:-2048 sc1
    s_waitcnt vmcnt(0)
    v_max_u32 v10, v24, v26
    v_cmp_eq_u32 vcc, -1, v10
    s_nop 0
    s_cbranch_vccz L_of1_2
    s_sub_u32 s47, s47, 1
    s_cbranch_scc0 L_or1_2
L_of1_2:
    global_load_dwordx4 v[28:31], v9, s[98:99] offset:-1024 sc1
    global_load_dwordx4 v[32:35], v9, s[98:99] offset:0 sc1
    global_load_dwordx4 v[36:39], v9, s[98:99] offset:1024 sc1
    global_load_dwordx4 v[40:43], v9, s[98:99] offset:2048 sc1
    global_load_dwordx4 v[48:51], v9, s[100:101] offset:-4096 sc1
    global_load_dwordx4 v[44:47], v9, s[98:99] offset:3072 sc1
    s_branch L_ob1_2
L_or1_3:
    global_load_dwordx4 v[28:31], v9, s[98:99] offset:-1024 sc1
    s_waitcnt vmcnt(0)
    v_max_u32 v10, v28, v30
    v_cmp_eq_u32 vcc, -1, v10
    s_nop 0
    s_cbranch_vccz L_of1_3
    s_sub_u32 s47, s47, 1
    s_cbranch_scc0 L_or1_3
L_of1_3:
    global_load_dwordx4 v[32:35], v9, s[98:99] offset:0 sc1
    global_load_dwordx4 v[36:39], v9, s[98:99] offset:1024 sc1
    global_load_dwordx4 v[40:43], v9, s[98:99] offset:2048 sc1
    global_load_dwordx4 v[48:51], v9, s[100:101] offset:-4096 sc1
    global_load_dwordx4 v[44:47], v9, s[98:99] offset:3072 sc1
    s_branch L_ob1_3
L_or1_4:
    global_load_dwordx4 v[32:35], v9, s[98:99] offset:0 sc1
    s_waitcnt vmcnt(0)
    v_max_u32 v10, v32, v34
    v_cmp_eq_u32 vcc, -1, v10
    s_nop 0
    s_cbranch_vccz L_of1_4
    s_sub_u32 s47, s47, 1
    s_cbranch_scc0 L_or1_4
L_of1_4:
    global_load_dwordx4 v[36:39], v9, s[98:99] offset:1024 sc1
    global_load_dwordx4 v[40:43], v9, s[98:99] offset:2048 sc1
    global_load_dwordx4 v[48:51], v9, s[100:101] offset:-4096 sc1
    global_load_dwordx4 v[44:47], v9, s[98:99] offset:3072 sc1
    s_branch L_ob1_4
L_or1_5:
    global_load_dwordx4 v[36:39], v9, s[98:99] offset:1024 sc1
    s_waitcnt vmcnt(0)
    v_max_u32 v10, v36, v38
    v_cmp_eq_u32 vcc, -1, v10
    s_nop 0
    s_cbranch_vccz L_of1_5
    s_sub_u32 s47, s47, 1
    s_cbranch_scc0 L_or1_5
L_of1_5:
    global_load_dwordx4 v[40:43], v9, s[98:99] offset:2048 sc1
    global_load_dwordx4 v[48:51], v9, s[100:101] offset:-4096 sc1
    global_load_dwordx4 v[44:47], v9, s[98:99] offset:3072 sc1
    s_branch L_ob1_5
L_or1_6:
    global_load_dwordx4 v[40:43], v9, s[98:99] offset:2048 sc1
    s_waitcnt vmcnt(0)
    v_max_u32 v10, v40, v42
    v_cmp_eq_u32 vcc, -1, v10
    s_nop 0
    s_cbranch_vccz L_of1_6
    s_sub_u32 s47, s47, 1
    s_cbranch_scc0 L_or1_6
L_of1_6:
    global_load_dwordx4 v[48:51], v9, s[100:101] offset:-4096 sc1
    global_load_dwordx4 v[44:47], v9, s[98:99] offset:3072 sc1
    s_branch L_ob1_6
L_or1_8:
    global_load_dwordx4 v[48:51], v9, s[100:101] offset:-4096 sc1
    s_waitcnt vmcnt(0)
    v_max_u32 v10, v48, v50
    v_cmp_eq_u32 vcc, -1, v10
    s_nop 0
    s_cbranch_vccz L_of1_8
    s_sub_u32 s47, s47, 1
    s_cbranch_scc0 L_or1_8
L_of1_8:
    global_load_dwordx4 v[44:47], v9, s[98:99] offset:3072 sc1
    s_branch L_ob1_8
L_or1_7:
    global_load_dwordx4 v[44:47], v9, s[98:99] offset:3072 sc1
    s_waitcnt vmcnt(0)
    v_max_u32 v10, v44, v46
    v_cmp_eq_u32 vcc, -1, v10
    s_nop 0
    s_cbranch_vccz L_of1_7
    s_sub_u32 s47, s47, 1
    s_cbranch_scc0 L_or1_7
L_of1_7:
    s_branch L_ob1_7
L_slow:
    s_waitcnt vmcnt(0) lgkmcnt(0)
    s_mov_b32 s44, 1
    v_mov_b32 v36, 0xff800000
    v_mov_b32 v37, 0xff800000
    v_mov_b32 v38, 0xff800000
    v_mov_b32 v39, 0xff800000
    s_mul_i32 s68, s39, 43008
    s_mov_b32 s69, 0
L_mx:
    buffer_load_dwordx4 v[40:43], v240, s[48:51], s68 offen offset:0 sc1
    buffer_load_dwordx4 v[44:47], v240, s[48:51], s68 offen offset:1024 sc1
    buffer_load_dwordx2 v[48:49], v241, s[48:51], s68 offen offset:2048 sc1
    s_waitcnt vmcnt(0)
    v_mfma_f32_32x32x4_2b_bf16 v[96:127], v[48:49], v[32:33], 0 cbsz:1 abid:0
    v_mfma_f32_32x32x4_2b_bf16 v[128:159], v[48:49], v[34:35], 0 cbsz:1 abid:0
    s_nop 15
    s_nop 0
    v_mfma_f32_32x32x16_bf16 v[96:111], v[40:43], v[16:19], v[96:111]
    v_mfma_f32_32x32x16_bf16 v[112:127], v[40:43], v[20:23], v[112:127]
    v_mfma_f32_32x32x16_bf16 v[128:143], v[40:43], v[24:27], v[128:143]
    v_mfma_f32_32x32x16_bf16 v[144:159], v[40:43], v[28:31], v[144:159]
    s_nop 8
    v_max3_f32 v36, v36, v96, v97
    v_max3_f32 v36, v36, v98, v99
    v_max3_f32 v36, v36, v100, v101
    v_max3_f32 v36, v36, v102, v103
    v_max3_f32 v36, v36, v104, v105
    v_max3_f32 v36, v36, v106, v107
    v_max3_f32 v36, v36, v108, v109
    v_max3_f32 v36, v36, v110, v111
    v_max3_f32 v37, v37, v112, v113
    v_max3_f32 v37, v37, v114, v115
    v_max3_f32 v37, v37, v116, v117
    v_max3_f32 v37, v37, v118, v119
    v_max3_f32 v37, v37, v120, v121
    v_max3_f32 v37, v37, v122, v123
    v_max3_f32 v37, v37, v124, v125
    v_max3_f32 v37, v37, v126, v127
    v_max3_f32 v38, v38, v128, v129
    v_max3_f32 v38, v38, v130, v131
    v_max3_f32 v38, v38, v132, v133
    v_max3_f32 v38, v38, v134, v135
    v_max3_f32 v38, v38, v136, v137
    v_max3_f32 v38, v38, v138, v139
    v_max3_f32 v38, v38, v140, v141
    v_max3_f32 v38, v38, v142, v143
    v_max3_f32 v39, v39, v144, v145
    v_max3_f32 v39, v39, v146, v147
    v_max3_f32 v39, v39, v148, v149
    v_max3_f32 v39, v39, v150, v151
    v_max3_f32 v39, v39, v152, v153
    v_max3_f32 v39, v39, v154, v155
    v_max3_f32 v39, v39, v156, v157
    v_max3_f32 v39, v39, v158, v159
    v_mfma_f32_32x32x4_2b_bf16 v[96:127], v[48:49], v[32:33], 0 cbsz:1 abid:1
    v_mfma_f32_32x32x4_2b_bf16 v[128:159], v[48:49], v[34:35], 0 cbsz:1 abid:1
    s_nop 15
    s_nop 0
    v_mfma_f32_32x32x16_bf16 v[96:111], v[44:47], v[16:19], v[96:111]
    v_mfma_f32_32x32x16_bf16 v[112:127], v[44:47], v[20:23], v[112:127]
    v_mfma_f32_32x32x16_bf16 v[128:143], v[44:47], v[24:27], v[128:143]
    v_mfma_f32_32x32x16_bf16 v[144:159], v[44:47], v[28:31], v[144:159]
    s_nop 8
    v_max3_f32 v36, v36, v96, v97
    v_max3_f32 v36, v36, v98, v99
    v_max3_f32 v36, v36, v100, v101
    v_max3_f32 v36, v36, v102, v103
    v_max3_f32 v36, v36, v104, v105
    v_max3_f32 v36, v36, v106, v107
    v_max3_f32 v36, v36, v108, v109
    v_max3_f32 v36, v36, v110, v111
    v_max3_f32 v37, v37, v112, v113
    v_max3_f32 v37, v37, v114, v115
    v_max3_f32 v37, v37, v116, v117
    v_max3_f32 v37, v37, v118, v119
    v_max3_f32 v37, v37, v120, v121
    v_max3_f32 v37, v37, v122, v123
    v_max3_f32 v37, v37, v124, v125
    v_max3_f32 v37, v37, v126, v127
    v_max3_f32 v38, v38, v128, v129
    v_max3_f32 v38, v38, v130, v131
    v_max3_f32 v38, v38, v132, v133
    v_max3_f32 v38, v38, v134, v135
    v_max3_f32 v38, v38, v136, v137
    v_max3_f32 v38, v38, v138, v139
    v_max3_f32 v38, v38, v140, v141
    v_max3_f32 v38, v38, v142, v143
    v_max3_f32 v39, v39, v144, v145
    v_max3_f32 v39, v39, v146, v147
    v_max3_f32 v39, v39, v148, v149
    v_max3_f32 v39, v39, v150, v151
    v_max3_f32 v39, v39, v152, v153
    v_max3_f32 v39, v39, v154, v155
    v_max3_f32 v39, v39, v156, v157
    v_max3_f32 v39, v39, v158, v159
    s_add_u32 s68, s68, 5376
    s_add_u32 s69, s69, 1
    s_cmp_lt_u32 s69, 8
    s_cbranch_scc1 L_mx
    v_mov_b32 v50, v36
    s_nop 1
    v_permlane32_swap_b32 v50, v36
    v_max_f32 v36, v50, v36
    v_lshrrev_b32 v50, 5, v1
    v_lshl_add_u32 v164, v50, 11, v252
    ds_write_b32 v164, v36
    v_mov_b32 v50, v37
    s_nop 1
    v_permlane32_swap_b32 v50, v37
    v_max_f32 v37, v50, v37
    v_lshrrev_b32 v50, 5, v1
    v_lshl_add_u32 v165, v50, 11, v253
    ds_write_b32 v165, v37
    v_mov_b32 v50, v38
    s_nop 1
    v_permlane32_swap_b32 v50, v38
    v_max_f32 v38, v50, v38
    v_lshrrev_b32 v50, 5, v1
    v_lshl_add_u32 v166, v50, 11, v254
    ds_write_b32 v166, v38
    v_mov_b32 v50, v39
    s_nop 1
    v_permlane32_swap_b32 v50, v39
    v_max_f32 v39, v50, v39
    v_lshrrev_b32 v50, 5, v1
    v_lshl_add_u32 v167, v50, 11, v255
    ds_write_b32 v167, v39
    s_add_u32 s45, s45, 4
    v_mov_b32 v226, s72
    v_mov_b32 v227, 1
    s_mov_b64 exec, 1
    ds_add_u32 v226, v227
    s_mov_b64 exec, -1
    s_mov_b32 s47, 1048576
L_lw_90:
    ds_read_b32 v225, v226
    s_waitcnt lgkmcnt(0)
    v_readfirstlane_b32 s63, v225
    s_nop 0
    s_cmp_ge_u32 s63, s45
    s_cbranch_scc1 L_lwr_91
    s_sub_u32 s47, s47, 1
    s_cbranch_scc0 L_lw_90
L_lwr_91:
L_lwe_92:
    s_lshl_b32 s58, s39, 2
    v_subrev_u32 v164, s58, v164
    ds_read_b128 v[96:99], v164
    v_subrev_u32 v165, s58, v165
    ds_read_b128 v[100:103], v165
    v_subrev_u32 v166, s58, v166
    ds_read_b128 v[104:107], v166
    v_subrev_u32 v167, s58, v167
    ds_read_b128 v[108:111], v167
    s_add_u32 s45, s45, 4
    v_mov_b32 v226, s72
    v_mov_b32 v227, 1
    s_mov_b64 exec, 1
    ds_add_u32 v226, v227
    s_mov_b64 exec, -1
    s_mov_b32 s47, 1048576
L_lw_93:
    ds_read_b32 v225, v226
    s_waitcnt lgkmcnt(0)
    v_readfirstlane_b32 s63, v225
    s_nop 0
    s_cmp_ge_u32 s63, s45
    s_cbranch_scc1 L_lwr_94
    s_sub_u32 s47, s47, 1
    s_cbranch_scc0 L_lw_93
L_lwr_94:
L_lwe_95:
    v_max3_f32 v96, v96, v97, v98
    v_max_f32 v36, v96, v99
    v_max3_f32 v100, v100, v101, v102
    v_max_f32 v37, v100, v103
    v_max3_f32 v104, v104, v105, v106
    v_max_f32 v38, v104, v107
    v_max3_f32 v108, v108, v109, v110
    v_max_f32 v39, v108, v111
    v_mov_b64 v[92:93], 0
    v_mov_b64 v[94:95], 0
    s_nop 0
    v_mfma_f32_32x32x8bf16_1k v[144:159], v[92:93], v[92:93], 0
    v_mfma_f32_32x32x8bf16_1k v[160:175], v[92:93], v[92:93], 0
    v_mfma_f32_32x32x8bf16_1k v[176:191], v[92:93], v[92:93], 0
    v_mfma_f32_32x32x8bf16_1k v[192:207], v[92:93], v[92:93], 0
    v_mfma_f32_32x32x8bf16_1k v[208:223], v[92:93], v[92:93], 0
    s_mul_i32 s68, s39, 43008
    s_mov_b32 s69, 0
L_p2:
    buffer_load_dwordx4 v[40:43], v240, s[48:51], s68 offen offset:0 sc1
    buffer_load_dwordx4 v[44:47], v240, s[48:51], s68 offen offset:1024 sc1
    buffer_load_dwordx2 v[48:49], v241, s[48:51], s68 offen offset:2048 sc1
    buffer_load_dwordx4 v[52:55], v242, s[48:51], s68 offen offset:0 sc1
    buffer_load_dwordx4 v[56:59], v242, s[48:51], s68 offen offset:672 sc1
    buffer_load_dwordx4 v[60:63], v242, s[48:51], s68 offen offset:1344 sc1
    buffer_load_dwordx4 v[64:67], v242, s[48:51], s68 offen offset:2016 sc1
    s_waitcnt vmcnt(0)
    v_mfma_f32_32x32x4_2b_bf16 v[96:127], v[48:49], v[32:33], 0 cbsz:1 abid:0
    v_mfma_f32_32x32x4_2b_bf16 v[128:159], v[48:49], v[34:35], 0 cbsz:1 abid:0
    s_nop 15
    s_nop 0
    v_mfma_f32_32x32x16_bf16 v[96:111], v[40:43], v[16:19], v[96:111]
    v_mfma_f32_32x32x16_bf16 v[112:127], v[40:43], v[20:23], v[112:127]
    v_mfma_f32_32x32x16_bf16 v[128:143], v[40:43], v[24:27], v[128:143]
    v_mfma_f32_32x32x16_bf16 v[144:159], v[40:43], v[28:31], v[144:159]
    s_nop 8
    v_sub_f32 v96, v96, v36
    v_sub_f32 v97, v97, v36
    v_sub_f32 v98, v98, v36
    v_sub_f32 v99, v99, v36
    v_sub_f32 v100, v100, v36
    v_sub_f32 v101, v101, v36
    v_sub_f32 v102, v102, v36
    v_sub_f32 v103, v103, v36
    v_sub_f32 v104, v104, v36
    v_sub_f32 v105, v105, v36
    v_sub_f32 v106, v106, v36
    v_sub_f32 v107, v107, v36
    v_sub_f32 v108, v108, v36
    v_sub_f32 v109, v109, v36
    v_sub_f32 v110, v110, v36
    v_sub_f32 v111, v111, v36
    v_exp_f32 v96, v96
    v_exp_f32 v97, v97
    v_exp_f32 v98, v98
    v_exp_f32 v99, v99
    v_exp_f32 v100, v100
    v_exp_f32 v101, v101
    v_exp_f32 v102, v102
    v_exp_f32 v103, v103
    v_exp_f32 v104, v104
    v_exp_f32 v105, v105
    v_exp_f32 v106, v106
    v_exp_f32 v107, v107
    v_exp_f32 v108, v108
    v_exp_f32 v109, v109
    v_exp_f32 v110, v110
    v_exp_f32 v111, v111
    v_smfmac_f32_32x32x32_bf16 v[160:175], v[52:55], v[96:103], v243
    s_nop 0
    v_smfmac_f32_32x32x32_bf16 v[160:175], v[56:59], v[104:111], v243
    v_sub_f32 v112, v112, v37
    v_sub_f32 v113, v113, v37
    v_sub_f32 v114, v114, v37
    v_sub_f32 v115, v115, v37
    v_sub_f32 v116, v116, v37
    v_sub_f32 v117, v117, v37
    v_sub_f32 v118, v118, v37
    v_sub_f32 v119, v119, v37
    v_sub_f32 v120, v120, v37
    v_sub_f32 v121, v121, v37
    v_sub_f32 v122, v122, v37
    v_sub_f32 v123, v123, v37
    v_sub_f32 v124, v124, v37
    v_sub_f32 v125, v125, v37
    v_sub_f32 v126, v126, v37
    v_sub_f32 v127, v127, v37
    v_exp_f32 v112, v112
    v_exp_f32 v113, v113
    v_exp_f32 v114, v114
    v_exp_f32 v115, v115
    v_exp_f32 v116, v116
    v_exp_f32 v117, v117
    v_exp_f32 v118, v118
    v_exp_f32 v119, v119
    v_exp_f32 v120, v120
    v_exp_f32 v121, v121
    v_exp_f32 v122, v122
    v_exp_f32 v123, v123
    v_exp_f32 v124, v124
    v_exp_f32 v125, v125
    v_exp_f32 v126, v126
    v_exp_f32 v127, v127
    v_smfmac_f32_32x32x32_bf16 v[176:191], v[52:55], v[112:119], v243
    s_nop 0
    v_smfmac_f32_32x32x32_bf16 v[176:191], v[56:59], v[120:127], v243
    v_sub_f32 v128, v128, v38
    v_sub_f32 v129, v129, v38
    v_sub_f32 v130, v130, v38
    v_sub_f32 v131, v131, v38
    v_sub_f32 v132, v132, v38
    v_sub_f32 v133, v133, v38
    v_sub_f32 v134, v134, v38
    v_sub_f32 v135, v135, v38
    v_sub_f32 v136, v136, v38
    v_sub_f32 v137, v137, v38
    v_sub_f32 v138, v138, v38
    v_sub_f32 v139, v139, v38
    v_sub_f32 v140, v140, v38
    v_sub_f32 v141, v141, v38
    v_sub_f32 v142, v142, v38
    v_sub_f32 v143, v143, v38
    v_exp_f32 v128, v128
    v_exp_f32 v129, v129
    v_exp_f32 v130, v130
    v_exp_f32 v131, v131
    v_exp_f32 v132, v132
    v_exp_f32 v133, v133
    v_exp_f32 v134, v134
    v_exp_f32 v135, v135
    v_exp_f32 v136, v136
    v_exp_f32 v137, v137
    v_exp_f32 v138, v138
    v_exp_f32 v139, v139
    v_exp_f32 v140, v140
    v_exp_f32 v141, v141
    v_exp_f32 v142, v142
    v_exp_f32 v143, v143
    v_smfmac_f32_32x32x32_bf16 v[192:207], v[52:55], v[128:135], v243
    s_nop 0
    v_smfmac_f32_32x32x32_bf16 v[192:207], v[56:59], v[136:143], v243
    v_sub_f32 v144, v144, v39
    v_sub_f32 v145, v145, v39
    v_sub_f32 v146, v146, v39
    v_sub_f32 v147, v147, v39
    v_sub_f32 v148, v148, v39
    v_sub_f32 v149, v149, v39
    v_sub_f32 v150, v150, v39
    v_sub_f32 v151, v151, v39
    v_sub_f32 v152, v152, v39
    v_sub_f32 v153, v153, v39
    v_sub_f32 v154, v154, v39
    v_sub_f32 v155, v155, v39
    v_sub_f32 v156, v156, v39
    v_sub_f32 v157, v157, v39
    v_sub_f32 v158, v158, v39
    v_sub_f32 v159, v159, v39
    v_exp_f32 v144, v144
    v_exp_f32 v145, v145
    v_exp_f32 v146, v146
    v_exp_f32 v147, v147
    v_exp_f32 v148, v148
    v_exp_f32 v149, v149
    v_exp_f32 v150, v150
    v_exp_f32 v151, v151
    v_exp_f32 v152, v152
    v_exp_f32 v153, v153
    v_exp_f32 v154, v154
    v_exp_f32 v155, v155
    v_exp_f32 v156, v156
    v_exp_f32 v157, v157
    v_exp_f32 v158, v158
    v_exp_f32 v159, v159
    v_smfmac_f32_32x32x32_bf16 v[208:223], v[52:55], v[144:151], v243
    s_nop 0
    v_smfmac_f32_32x32x32_bf16 v[208:223], v[56:59], v[152:159], v243
    v_mfma_f32_32x32x4_2b_bf16 v[96:127], v[48:49], v[32:33], 0 cbsz:1 abid:1
    v_mfma_f32_32x32x4_2b_bf16 v[128:159], v[48:49], v[34:35], 0 cbsz:1 abid:1
    s_nop 15
    s_nop 0
    v_mfma_f32_32x32x16_bf16 v[96:111], v[44:47], v[16:19], v[96:111]
    v_mfma_f32_32x32x16_bf16 v[112:127], v[44:47], v[20:23], v[112:127]
    v_mfma_f32_32x32x16_bf16 v[128:143], v[44:47], v[24:27], v[128:143]
    v_mfma_f32_32x32x16_bf16 v[144:159], v[44:47], v[28:31], v[144:159]
    s_nop 8
    v_sub_f32 v96, v96, v36
    v_sub_f32 v97, v97, v36
    v_sub_f32 v98, v98, v36
    v_sub_f32 v99, v99, v36
    v_sub_f32 v100, v100, v36
    v_sub_f32 v101, v101, v36
    v_sub_f32 v102, v102, v36
    v_sub_f32 v103, v103, v36
    v_sub_f32 v104, v104, v36
    v_sub_f32 v105, v105, v36
    v_sub_f32 v106, v106, v36
    v_sub_f32 v107, v107, v36
    v_sub_f32 v108, v108, v36
    v_sub_f32 v109, v109, v36
    v_sub_f32 v110, v110, v36
    v_sub_f32 v111, v111, v36
    v_exp_f32 v96, v96
    v_exp_f32 v97, v97
    v_exp_f32 v98, v98
    v_exp_f32 v99, v99
    v_exp_f32 v100, v100
    v_exp_f32 v101, v101
    v_exp_f32 v102, v102
    v_exp_f32 v103, v103
    v_exp_f32 v104, v104
    v_exp_f32 v105, v105
    v_exp_f32 v106, v106
    v_exp_f32 v107, v107
    v_exp_f32 v108, v108
    v_exp_f32 v109, v109
    v_exp_f32 v110, v110
    v_exp_f32 v111, v111
    v_smfmac_f32_32x32x32_bf16 v[160:175], v[60:63], v[96:103], v243
    s_nop 0
    v_smfmac_f32_32x32x32_bf16 v[160:175], v[64:67], v[104:111], v243
    v_sub_f32 v112, v112, v37
    v_sub_f32 v113, v113, v37
    v_sub_f32 v114, v114, v37
    v_sub_f32 v115, v115, v37
    v_sub_f32 v116, v116, v37
    v_sub_f32 v117, v117, v37
    v_sub_f32 v118, v118, v37
    v_sub_f32 v119, v119, v37
    v_sub_f32 v120, v120, v37
    v_sub_f32 v121, v121, v37
    v_sub_f32 v122, v122, v37
    v_sub_f32 v123, v123, v37
    v_sub_f32 v124, v124, v37
    v_sub_f32 v125, v125, v37
    v_sub_f32 v126, v126, v37
    v_sub_f32 v127, v127, v37
    v_exp_f32 v112, v112
    v_exp_f32 v113, v113
    v_exp_f32 v114, v114
    v_exp_f32 v115, v115
    v_exp_f32 v116, v116
    v_exp_f32 v117, v117
    v_exp_f32 v118, v118
    v_exp_f32 v119, v119
    v_exp_f32 v120, v120
    v_exp_f32 v121, v121
    v_exp_f32 v122, v122
    v_exp_f32 v123, v123
    v_exp_f32 v124, v124
    v_exp_f32 v125, v125
    v_exp_f32 v126, v126
    v_exp_f32 v127, v127
    v_smfmac_f32_32x32x32_bf16 v[176:191], v[60:63], v[112:119], v243
    s_nop 0
    v_smfmac_f32_32x32x32_bf16 v[176:191], v[64:67], v[120:127], v243
    v_sub_f32 v128, v128, v38
    v_sub_f32 v129, v129, v38
    v_sub_f32 v130, v130, v38
    v_sub_f32 v131, v131, v38
    v_sub_f32 v132, v132, v38
    v_sub_f32 v133, v133, v38
    v_sub_f32 v134, v134, v38
    v_sub_f32 v135, v135, v38
    v_sub_f32 v136, v136, v38
    v_sub_f32 v137, v137, v38
    v_sub_f32 v138, v138, v38
    v_sub_f32 v139, v139, v38
    v_sub_f32 v140, v140, v38
    v_sub_f32 v141, v141, v38
    v_sub_f32 v142, v142, v38
    v_sub_f32 v143, v143, v38
    v_exp_f32 v128, v128
    v_exp_f32 v129, v129
    v_exp_f32 v130, v130
    v_exp_f32 v131, v131
    v_exp_f32 v132, v132
    v_exp_f32 v133, v133
    v_exp_f32 v134, v134
    v_exp_f32 v135, v135
    v_exp_f32 v136, v136
    v_exp_f32 v137, v137
    v_exp_f32 v138, v138
    v_exp_f32 v139, v139
    v_exp_f32 v140, v140
    v_exp_f32 v141, v141
    v_exp_f32 v142, v142
    v_exp_f32 v143, v143
    v_smfmac_f32_32x32x32_bf16 v[192:207], v[60:63], v[128:135], v243
    s_nop 0
    v_smfmac_f32_32x32x32_bf16 v[192:207], v[64:67], v[136:143], v243
    v_sub_f32 v144, v144, v39
    v_sub_f32 v145, v145, v39
    v_sub_f32 v146, v146, v39
    v_sub_f32 v147, v147, v39
    v_sub_f32 v148, v148, v39
    v_sub_f32 v149, v149, v39
    v_sub_f32 v150, v150, v39
    v_sub_f32 v151, v151, v39
    v_sub_f32 v152, v152, v39
    v_sub_f32 v153, v153, v39
    v_sub_f32 v154, v154, v39
    v_sub_f32 v155, v155, v39
    v_sub_f32 v156, v156, v39
    v_sub_f32 v157, v157, v39
    v_sub_f32 v158, v158, v39
    v_sub_f32 v159, v159, v39
    v_exp_f32 v144, v144
    v_exp_f32 v145, v145
    v_exp_f32 v146, v146
    v_exp_f32 v147, v147
    v_exp_f32 v148, v148
    v_exp_f32 v149, v149
    v_exp_f32 v150, v150
    v_exp_f32 v151, v151
    v_exp_f32 v152, v152
    v_exp_f32 v153, v153
    v_exp_f32 v154, v154
    v_exp_f32 v155, v155
    v_exp_f32 v156, v156
    v_exp_f32 v157, v157
    v_exp_f32 v158, v158
    v_exp_f32 v159, v159
    v_smfmac_f32_32x32x32_bf16 v[208:223], v[60:63], v[144:151], v243
    s_nop 0
    v_smfmac_f32_32x32x32_bf16 v[208:223], v[64:67], v[152:159], v243
    s_add_u32 s68, s68, 5376
    s_add_u32 s69, s69, 1
    s_cmp_lt_u32 s69, 8
    s_cbranch_scc1 L_p2
    s_add_u32 s45, s45, 4
    ds_write_b128 v248, v[160:163] offset:0
    ds_write_b128 v248, v[164:167] offset:1024
    ds_write_b128 v248, v[168:171] offset:2048
    ds_write_b32 v252, v168
    ds_write_b128 v249, v[176:179] offset:3072
    ds_write_b128 v249, v[180:183] offset:4096
    ds_write_b128 v249, v[184:187] offset:5120
    ds_write_b32 v253, v184
    s_branch L_send
L_codeend:
.section .rodata,"a"
.p2align 6
.amdhsa_kernel adaLN_cond__grouped_kv_mqa__moe_arch_mod__prompt_kernel
  .amdhsa_next_free_vgpr 256
  .amdhsa_next_free_sgpr 102
  .amdhsa_accum_offset 256
  .amdhsa_group_segment_fixed_size 0
  .amdhsa_kernarg_size 120
  .amdhsa_user_sgpr_count 2
  .amdhsa_user_sgpr_kernarg_segment_ptr 1
  .amdhsa_system_sgpr_workgroup_id_x 1
  .amdhsa_float_denorm_mode_32 3
.end_amdhsa_kernel
```
